```python
import torch

def _softmax(x, axis=-1):
    return torch.softmax(x, dim=axis)
def _gelu(x):
    return torch.nn.functional.gelu(x, approximate="tanh")
def _silu(x):
    return torch.nn.functional.silu(x)
def _sigmoid(x):
    return torch.sigmoid(x)
def _layernorm(x, axis=-1, eps=1e-5):
    m = x.mean(dim=axis, keepdim=True)
    v = x.var(dim=axis, keepdim=True, unbiased=False)
    return (x - m) / torch.sqrt(v + eps)
def _scatter_add(tgt, idx, src, axis=0):
    return tgt.clone().index_add_(axis, idx, src)
def _segment_sum(src, seg, n):
    out = torch.zeros((n,) + src.shape[1:], dtype=src.dtype)
    return out.index_add_(0, seg, src)
def _pad(x, pw):
    flat = tuple(v for pair in reversed(pw) for v in pair)
    return torch.nn.functional.pad(x, flat)

kernel_name = 'recurrent_scan__compressed_kv_cla__glu_gated_swiglu__decode'

def setup_inputs():

    _w = (lambda a: (lambda t: t.to(torch.bfloat16) if t.is_floating_point() else t)(torch.as_tensor(a)))
    def _A_setup():
        B, H, Sq, Sk, D, M = 2, 32, 1, 8192, 128, 512
        Dc = 4 * D
        return {
            "x": _w((lambda *s: torch.randn(*s, dtype=torch.bfloat16) * 0.05)(B, Sq, M)),
            "c_kv": _w((lambda *s: torch.randn(*s, dtype=torch.bfloat16) * 1.6)(B, Sk, Dc)),
            "w_q": _w((lambda *s: torch.randn(*s, dtype=torch.bfloat16) * 1.6)(M, H, D) * (M ** -0.5)),
            "w_uk": _w((lambda *s: torch.randn(*s, dtype=torch.bfloat16) * 1.6)(Dc, H, D) * (Dc ** -0.5)),
            "w_uv": _w((lambda *s: torch.randn(*s, dtype=torch.bfloat16) * 1.6)(Dc, H, D) * (Dc ** -0.5)),
            "w_o": _w((lambda *s: torch.randn(*s, dtype=torch.bfloat16) * 1.6)(H, D, M) * ((H * D) ** -0.5)),
        }
    _A_in = _A_setup()

    def _B_setup():
        B, S, D, F = 2, 1, 512, 1376
        return {
            "x": _w((lambda *s: torch.randn(*s, dtype=torch.bfloat16) * 0.05)(B, S, D)),
            "w1": _w((lambda *s: torch.randn(*s, dtype=torch.bfloat16) * 0.2)(D, F) * (2.0 / D) ** 0.5),
            "w3": _w((lambda *s: torch.randn(*s, dtype=torch.bfloat16) * 0.2)(D, F) * (2.0 / D) ** 0.5),
            "w2": _w((lambda *s: torch.randn(*s, dtype=torch.bfloat16) * 0.2)(F, D) * (2.0 / F) ** 0.5),
        }
    _B_in = _B_setup()

    return {
        "A_x": _A_in["x"],
        "A_c_kv": _A_in["c_kv"],
        "A_w_q": _A_in["w_q"],
        "A_w_uk": _A_in["w_uk"],
        "A_w_uv": _A_in["w_uv"],
        "A_w_o": _A_in["w_o"],
        "B_x": _B_in["x"],
        "B_w1": _B_in["w1"],
        "B_w3": _B_in["w3"],
        "B_w2": _B_in["w2"],
    }

def reference(A_x, A_c_kv, A_w_q, A_w_uk, A_w_uv, A_w_o, B_x, B_w1, B_w3, B_w2):
    def _A_ref(x, c_kv, w_q, w_uk, w_uv, w_o):
        B, Sq, M = x.shape[0], x.shape[1], x.shape[2]
        Sk = c_kv.shape[1]
        H, D = w_q.shape[1], w_q.shape[2]
        q = torch.einsum("bqm,mhd->bhqd", x, w_q)
        k = torch.einsum("bkc,chd->bhkd", c_kv, w_uk)
        v = torch.einsum("bkc,chd->bhkd", c_kv, w_uv)
        scores = torch.einsum("bhqd,bhkd->bhqk", q, k) * (D ** -0.5)
        off = Sk - Sq
        qi = torch.arange(Sq)[:, None]
        kj = torch.arange(Sk)[None, :]
        cmask = kj <= (qi + off)
        scores = torch.where(cmask[None, None], scores, -1e9)
        p = _softmax(scores, axis=-1)
        ctx = torch.einsum("bhqk,bhkd->bhqd", p, v)
        return torch.einsum("bhqd,hdm->bqm", ctx, w_o)

    def _B_ref(x, w1, w3, w2):
        gate = torch.einsum("bsd,df->bsf", x, w1)
        up = torch.einsum("bsd,df->bsf", x, w3)
        h = _silu(gate) * up
        out = torch.einsum("bsf,fd->bsd", h, w2)
        return out

    x = A_x
    xn = _layernorm(x, axis=-1)
    s = _A_ref(xn, A_c_kv, A_w_q, A_w_uk, A_w_uv, A_w_o)
    g = _silu(_B_ref(xn, B_w1, B_w3, B_w2))
    return x + s * g
```

```asm
; @launch grid=(256,1,1) block=(512,1,1) lds=163840
.amdgcn_target "amdgcn-amd-amdhsa--gfx950"
.text
.globl recurrent_scan__compressed_kv_cla__glu_gated_swiglu__decode_kernel
.p2align 8
.type recurrent_scan__compressed_kv_cla__glu_gated_swiglu__decode_kernel,@function
recurrent_scan__compressed_kv_cla__glu_gated_swiglu__decode_kernel:
    s_cmp_ge_u32 s2, 128
    s_cbranch_scc1 .L_A
    s_load_dwordx2 s[12:13], s[0:1], 88
    s_memrealtime s[48:49]
    s_load_dwordx2 s[16:17], s[0:1], 16
    s_load_dwordx2 s[4:5], s[0:1], 0
    s_load_dwordx2 s[20:21], s[0:1], 24
    s_load_dwordx2 s[8:9], s[0:1], 96
    v_lshrrev_b32 v1, 6, v0
    v_and_b32 v0, 63, v0
    v_readfirstlane_b32 s3, v1
    s_and_b32 s41, s2, 7
    s_lshl_b32 s41, s41, 2
    s_lshr_b32 s43, s2, 5
    s_add_u32 s41, s41, s43
    s_bfe_u32 s42, s2, 0x20003
    s_mov_b32 s18, 4194304
    s_mov_b32 s19, 0x20000
    s_mov_b32 s6, 2048
    s_mov_b32 s7, 0x20000
    s_mov_b32 s14, 256
    s_mov_b32 s15, 0x20000
    s_mov_b32 s22, 4194304
    s_mov_b32 s23, 0x20000
    s_mov_b32 s10, 268435456
    s_mov_b32 s11, 0x20000
    v_lshrrev_b32 v2, 4, v0
    v_and_b32 v3, 15, v0
    v_lshlrev_b32 v4, 1, v2
    v_xor_b32 v4, v3, v4
    v_lshlrev_b32 v4, 4, v4
    v_lshl_add_u32 v5, v2, 13, v4
    v_xor_b32 v6, 0x80, v5
    s_lshl_b32 s44, s42, 20
    s_lshl_b32 s43, s3, 17
    s_add_u32 s44, s44, s43
    s_lshl_b32 s45, s41, 8
    s_add_u32 s44, s44, s45
    s_lshl_b32 s46, s3, 12
    v_lshlrev_b32 v8, 4, v0
    v_mov_b32 v9, 0
    s_lshl_b32 s47, s3, 10
    s_mov_b32 m0, s46
    s_or_b32 s45, s2, s3
    s_cmp_lg_u32 s45, 0
    s_waitcnt lgkmcnt(0)
    s_cbranch_scc1 .LW_nogen
    s_mul_i32 s48, s48, 0x9E3779B1
    s_lshr_b32 s49, s48, 15
    s_xor_b32 s48, s48, s49
    s_mul_i32 s48, s48, 0x85EBCA6B
    s_lshr_b32 s49, s48, 13
    s_xor_b32 s48, s48, s49
    s_max_u32 s48, s48, 1
    v_mov_b32 v12, s48
    v_lshlrev_b32 v13, 7, v0
    s_mov_b64 exec, 3
    buffer_store_dword v12, v13, s[12:15], 0 offen sc1
    s_mov_b64 exec, -1
.LW_nogen:
    s_lshl_b32 s49, s41, 12
    s_cmp_gt_u32 s3, 1
    s_cbranch_scc1 .LW_nox
    buffer_load_dwordx4 v[12:15], v8, s[4:7], s47 offen
.LW_nox:
    s_mov_b32 s45, s44
    buffer_load_dwordx4 v5, s[16:19], s45 offen nt lds
    s_add_u32 m0, m0, 1024
    s_add_u32 s45, s45, 32768
    buffer_load_dwordx4 v5, s[16:19], s45 offen nt lds
    s_add_u32 m0, m0, 1024
    s_add_u32 s45, s45, 32768
    buffer_load_dwordx4 v6, s[16:19], s45 offen nt lds
    s_add_u32 m0, m0, 1024
    s_add_u32 s45, s45, 32768
    buffer_load_dwordx4 v6, s[16:19], s45 offen nt lds
    s_cmp_lg_u32 s3, 2
    s_cbranch_scc1 .LW_nowarm
    s_lshl_b32 s45, s42, 10
    s_add_u32 s45, s45, s49
    buffer_load_dwordx4 v[12:15], v8, s[8:11], s45 offen sc1
.LW_nowarm:
    v_xor_b32 v7, v3, v2
    v_lshlrev_b32 v7, 4, v7
    v_lshl_add_u32 v7, v2, 13, v7
    s_add_u32 m0, s46, 0x8000
    s_mov_b32 s45, s44
    buffer_load_dwordx4 v7, s[20:23], s45 offen nt lds
    v_xor_b32 v10, 64, v7
    s_add_u32 m0, m0, 1024
    s_add_u32 s45, s45, 32768
    buffer_load_dwordx4 v10, s[20:23], s45 offen nt lds
    v_xor_b32 v10, 128, v7
    s_add_u32 m0, m0, 1024
    s_add_u32 s45, s45, 32768
    buffer_load_dwordx4 v10, s[20:23], s45 offen nt lds
    v_xor_b32 v10, 192, v7
    s_add_u32 m0, m0, 1024
    s_add_u32 s45, s45, 32768
    buffer_load_dwordx4 v10, s[20:23], s45 offen nt lds
    s_load_dwordx2 s[24:25], s[0:1], 32
    s_load_dwordx2 s[28:29], s[0:1], 40
    s_load_dwordx4 s[36:39], s[0:1], 56
    s_mov_b32 s26, 4194304
    s_mov_b32 s27, 0x20000
    s_mov_b32 s30, 4194304
    s_mov_b32 s31, 0x20000
    v_and_b32 v25, 1, v0
    s_cmp_gt_u32 s3, 1
    s_cbranch_scc1 .LW_noln
    s_waitcnt vmcnt(8)
    v_lshlrev_b32 v40, 16, v12
    v_and_b32 v41, 0xffff0000, v12
    v_lshlrev_b32 v42, 16, v13
    v_and_b32 v43, 0xffff0000, v13
    v_lshlrev_b32 v44, 16, v14
    v_and_b32 v45, 0xffff0000, v14
    v_lshlrev_b32 v46, 16, v15
    v_and_b32 v47, 0xffff0000, v15
    v_add_f32 v48, v40, v41
    v_add_f32 v49, v42, v43
    v_add_f32 v50, v44, v45
    v_add_f32 v48, v48, v46
    v_add_f32 v49, v49, v47
    v_add_f32 v48, v48, v50
    v_add_f32 v48, v48, v49
    s_nop 1
    v_add_f32_dpp v48, v48, v48 row_ror:8 row_mask:0xf bank_mask:0xf
    s_nop 1
    v_add_f32_dpp v48, v48, v48 row_ror:4 row_mask:0xf bank_mask:0xf
    s_nop 1
    v_add_f32_dpp v48, v48, v48 row_ror:2 row_mask:0xf bank_mask:0xf
    s_nop 1
    v_add_f32_dpp v48, v48, v48 row_ror:1 row_mask:0xf bank_mask:0xf
    v_mov_b32 v49, v48
    s_nop 1
    v_permlane16_swap_b32 v48, v49
    v_add_f32 v48, v48, v49
    v_mov_b32 v49, v48
    s_nop 1
    v_permlane32_swap_b32 v48, v49
    v_add_f32 v48, v48, v49
    v_mul_f32 v48, 0x3b000000, v48
    v_sub_f32 v49, v40, v48
    v_mul_f32 v51, v49, v49
    v_sub_f32 v49, v41, v48
    v_fmac_f32 v51, v49, v49
    v_sub_f32 v49, v42, v48
    v_fmac_f32 v51, v49, v49
    v_sub_f32 v49, v43, v48
    v_fmac_f32 v51, v49, v49
    v_sub_f32 v49, v44, v48
    v_fmac_f32 v51, v49, v49
    v_sub_f32 v49, v45, v48
    v_fmac_f32 v51, v49, v49
    v_sub_f32 v49, v46, v48
    v_fmac_f32 v51, v49, v49
    v_sub_f32 v49, v47, v48
    v_fmac_f32 v51, v49, v49
    s_nop 1
    v_add_f32_dpp v51, v51, v51 row_ror:8 row_mask:0xf bank_mask:0xf
    s_nop 1
    v_add_f32_dpp v51, v51, v51 row_ror:4 row_mask:0xf bank_mask:0xf
    s_nop 1
    v_add_f32_dpp v51, v51, v51 row_ror:2 row_mask:0xf bank_mask:0xf
    s_nop 1
    v_add_f32_dpp v51, v51, v51 row_ror:1 row_mask:0xf bank_mask:0xf
    v_mov_b32 v49, v51
    s_nop 1
    v_permlane16_swap_b32 v51, v49
    v_add_f32 v51, v51, v49
    v_mov_b32 v49, v51
    s_nop 1
    v_permlane32_swap_b32 v51, v49
    v_add_f32 v51, v51, v49
    v_mul_f32 v51, 0x3b000000, v51
    v_cvt_pk_bf16_f32 v49, v48, v51
    v_lshlrev_b32 v48, 16, v49
    v_and_b32 v51, 0xffff0000, v49
    v_add_f32 v51, 0x3727c5ac, v51
    v_cvt_pk_bf16_f32 v51, v51, v51
    v_and_b32 v51, 0xffff0000, v51
    v_sqrt_f32 v51, v51
    v_sub_f32 v40, v40, v48
    v_sub_f32 v41, v41, v48
    v_sub_f32 v42, v42, v48
    v_sub_f32 v43, v43, v48
    v_sub_f32 v44, v44, v48
    v_sub_f32 v45, v45, v48
    v_sub_f32 v46, v46, v48
    v_sub_f32 v47, v47, v48
    v_cvt_pk_bf16_f32 v51, v51, v51
    v_and_b32 v51, 0xffff0000, v51
    v_rcp_f32 v51, v51
    v_cvt_pk_bf16_f32 v16, v40, v41
    v_cvt_pk_bf16_f32 v17, v42, v43
    v_cvt_pk_bf16_f32 v18, v44, v45
    v_cvt_pk_bf16_f32 v19, v46, v47
    v_lshlrev_b32 v40, 16, v16
    v_and_b32 v41, 0xffff0000, v16
    v_lshlrev_b32 v42, 16, v17
    v_and_b32 v43, 0xffff0000, v17
    v_lshlrev_b32 v44, 16, v18
    v_and_b32 v45, 0xffff0000, v18
    v_lshlrev_b32 v46, 16, v19
    v_and_b32 v47, 0xffff0000, v19
    v_mul_f32 v40, v40, v51
    v_mul_f32 v41, v41, v51
    v_mul_f32 v42, v42, v51
    v_mul_f32 v43, v43, v51
    v_mul_f32 v44, v44, v51
    v_mul_f32 v45, v45, v51
    v_mul_f32 v46, v46, v51
    v_mul_f32 v47, v47, v51
    v_cvt_pk_bf16_f32 v16, v40, v41
    v_cvt_pk_bf16_f32 v17, v42, v43
    v_cvt_pk_bf16_f32 v18, v44, v45
    v_cvt_pk_bf16_f32 v19, v46, v47
    s_mul_i32 s45, s3, 1088
    s_add_u32 s45, s45, 131072
    v_add_u32 v10, s45, v8
    ds_write_b128 v10, v[16:19]
.LW_noln:
    s_sub_u32 s97, s2, 64
    s_and_b32 s97, s97, 127
    s_cmp_lt_u32 s97, 88
    s_cselect_b32 s62, s3, 4
    s_lshr_b32 s62, s62, 2
    s_xor_b32 s62, s62, 1
    s_and_b32 s63, s2, 7
    s_lshl_b32 s63, s63, 1
    s_bfe_u32 s45, s3, 0x10001
    s_add_u32 s63, s63, s45
    v_mul_u32_u24 v26, 1088, v25
    v_lshl_add_u32 v26, v2, 4, v26
    s_lshl_b32 s45, s63, 6
    s_add_u32 s45, s45, 131072
    v_add_u32 v23, s45, v26
    s_lshl_b32 s45, s42, 8
    s_add_u32 s45, s45, 131072
    v_add_u32 v24, s45, v26
    v_lshrrev_b32 v20, 2, v3
    v_and_b32 v21, 1, v2
    v_lshlrev_b32 v21, 3, v21
    v_lshl_add_u32 v21, v20, 1, v21
    v_bfe_u32 v22, v0, 1, 1
    s_lshl_b32 s45, s3, 1
    v_add_u32 v22, s45, v22
    v_xor_b32 v22, v22, v21
    v_lshlrev_b32 v22, 4, v22
    v_lshl_add_u32 v20, v2, 3, v20
    v_lshl_add_u32 v22, v20, 8, v22
    v_lshl_add_u32 v11, v25, 3, v22
    v_lshlrev_b32 v16, 9, v25
    v_lshl_add_u32 v16, v2, 4, v16
    s_lshl_b32 s51, s42, 10
    s_lshl_b32 s45, s3, 6
    s_add_u32 s51, s51, s45
    s_add_u32 s51, s51, s49
    s_lshl_b32 s50, s41, 2
    s_add_u32 s50, s50, s42
    v_mul_u32_u24 v26, 272, v25
    v_lshl_add_u32 v26, v2, 4, v26
    v_lshrrev_b32 v21, 3, v0
    v_lshlrev_b32 v1, 10, v21
    v_cmp_ne_u32 s[98:99], s42, v21
    v_bfe_u32 v21, v0, 2, 1
    v_lshl_add_u32 v1, v21, 9, v1
    v_and_b32 v22, 3, v0
    v_lshl_add_u32 v1, v22, 4, v1
    s_mov_b32 s99, 0
    v_lshl_add_u32 v29, v22, 4, v21
    v_lshlrev_b32 v29, 2, v29
    v_mul_u32_u24 v21, 272, v21
    v_lshl_add_u32 v22, v22, 3, v21
    s_lshl_b32 s45, s3, 5
    v_add_u32 v22, s45, v22
    v_bfe_u32 v21, v0, 4, 1
    v_lshl_add_u32 v22, v21, 2, v22
    s_lshl_b32 s57, s3, 6
    s_add_u32 s57, s57, s49
    v_xor_b32 v21, v2, v3
    v_lshlrev_b32 v21, 4, v21
    v_lshl_add_u32 v21, v3, 8, v21
    v_add_u32 v21, s46, v21
    s_waitcnt vmcnt(6)
    s_load_dword s40, s[12:13], 0
    s_waitcnt vmcnt(4) lgkmcnt(0)
    s_mov_b32 s96, 4000000
.LW_nchk:
    s_cmp_lg_u32 s40, 0
    s_cbranch_scc1 .LW_ngot
    s_sub_u32 s96, s96, 1
    s_cbranch_scc1 .LW_ngot
    buffer_load_dword v27, v9, s[12:15], 0 offen offset:128 sc1
    s_waitcnt vmcnt(0)
    v_readfirstlane_b32 s40, v27
    s_branch .LW_nchk
.LW_ngot:
    v_mov_b32 v27, s40
    s_barrier
    ds_read_b128 v[32:35], v24 offset:0
    ds_read_b64_tr_b16 v[48:49], v11 offset:0
    ds_read_b64_tr_b16 v[50:51], v11 offset:1024
    ds_read_b128 v[36:39], v24 offset:64
    ds_read_b64_tr_b16 v[52:53], v11 offset:8192
    ds_read_b64_tr_b16 v[54:55], v11 offset:9216
    ds_read_b128 v[40:43], v24 offset:128
    ds_read_b64_tr_b16 v[56:57], v11 offset:16384
    ds_read_b64_tr_b16 v[58:59], v11 offset:17408
    ds_read_b128 v[44:47], v24 offset:192
    ds_read_b64_tr_b16 v[60:61], v11 offset:24576
    ds_read_b64_tr_b16 v[62:63], v11 offset:25600
    ds_read_b128 v[128:131], v23
    v_add_u32 v23, 0x10000, v22
    v_add_u32 v24, 0x10000, v26
    s_mov_b32 s100, 0x9E3779B1
    v_mul_lo_u32 v19, v27, s100
    v_lshrrev_b32 v18, 12, v27
    v_mov_b32 v17, v27
    v_lshrrev_b32 v20, 20, v19
    v_lshrrev_b32 v19, 8, v19
    s_movk_i32 s100, 0xfff
    s_getreg_b32 s101, hwreg(HW_REG_XCC_ID, 0, 4)
    s_add_u32 s101, s101, 1
    v_xor_b32 v200, s101, v17
    v_xor_b32 v201, s101, v18
    v_xor_b32 v202, s101, v19
    v_xor_b32 v203, s101, v20
    v_and_b32 v28, 3, v0
    v_lshlrev_b32 v28, 3, v28
    v_lshrrev_b32 v28, v28, v27
    s_waitcnt lgkmcnt(10)
    v_mfma_f32_16x16x32_bf16 v[192:195], v[48:51], v[32:35], 0
    s_waitcnt lgkmcnt(7)
    v_mfma_f32_16x16x32_bf16 v[196:199], v[52:55], v[36:39], 0
    s_waitcnt lgkmcnt(4)
    v_mfma_f32_16x16x32_bf16 v[192:195], v[56:59], v[40:43], v[192:195]
    s_waitcnt lgkmcnt(1)
    v_mfma_f32_16x16x32_bf16 v[196:199], v[60:63], v[44:47], v[196:199]
    s_mov_b32 s45, s51
    s_mov_b32 s47, s57
    s_mov_b32 s96, 4000000
    v_mov_b32 v204, v200
    v_mov_b32 v205, v201
    v_mov_b32 v206, v202
    v_mov_b32 v207, v203
    s_nop 0
    v_add_f32 v192, v192, v196
    v_add_f32 v193, v193, v197
    v_add_f32 v194, v194, v198
    v_add_f32 v195, v195, v199
    s_mov_b32 exec_lo, 0x00030003
    s_mov_b32 exec_hi, 0x00030003
    v_bfi_b32 v196, s100, v200, v192
    v_bfi_b32 v197, s100, v201, v193
    v_bfi_b32 v198, s100, v202, v194
    v_bfi_b32 v199, s100, v203, v195
    buffer_store_dwordx4 v[196:199], v16, s[8:11], s45 offen
    s_mov_b64 exec, -1
    ds_bpermute_b32 v40, v29, v192
    ds_bpermute_b32 v41, v29, v193
    ds_bpermute_b32 v42, v29, v194
    ds_bpermute_b32 v43, v29, v195
    s_mov_b64 exec, s[98:99]
.LW_h1_p:
    buffer_load_dwordx4 v[32:35], v1, s[8:11], s47 offen sc1
    s_waitcnt vmcnt(0)
    v_xor_b32 v36, v32, v204
    v_bitop3_b32 v36, v36, v33, v205 bitop3:0xf6
    v_bitop3_b32 v36, v36, v34, v206 bitop3:0xf6
    v_bitop3_b32 v36, v36, v35, v207 bitop3:0xf6
    v_and_b32 v36, 0xfff, v36
    v_cmp_ne_u32 vcc, 0, v36
    s_cbranch_vccz .LW_h1_g
    s_sub_u32 s96, s96, 1
    s_cbranch_scc1 .LW_h1_g
    s_sleep 1
    s_cmp_gt_u32 s96, 3999986
    s_cbranch_scc1 .LW_h1_p
    s_xor_b32 s47, s47, 262144
    v_xor_b32 v204, s101, v204
    v_xor_b32 v205, s101, v205
    v_xor_b32 v206, s101, v206
    v_xor_b32 v207, s101, v207
    s_cmp_lg_u32 s96, 3999986
    s_cbranch_scc1 .LW_h1_p
    s_add_u32 s45, s51, 262144
    s_mov_b32 exec_lo, 0x00030003
    s_mov_b32 exec_hi, 0x00030003
    v_bfi_b32 v196, s100, v17, v192
    v_bfi_b32 v197, s100, v18, v193
    v_bfi_b32 v198, s100, v19, v194
    v_bfi_b32 v199, s100, v20, v195
    buffer_store_dwordx4 v[196:199], v16, s[8:11], s45 offen sc1
    s_mov_b64 exec, -1
    s_mov_b64 exec, s[98:99]
    s_branch .LW_h1_p
.LW_h1_g:
    s_mov_b64 exec, -1
    s_waitcnt lgkmcnt(0)
    v_cndmask_b32 v32, v40, v32, s[98:99]
    v_cndmask_b32 v33, v41, v33, s[98:99]
    v_cndmask_b32 v34, v42, v34, s[98:99]
    v_cndmask_b32 v35, v43, v35, s[98:99]
    s_nop 0
    v_permlane16_swap_b32 v32, v34
    v_permlane16_swap_b32 v33, v35
    v_add_f32 v32, v32, v34
    v_add_f32 v33, v33, v35
    s_nop 1
    v_add_f32_dpp v32, v32, v32 row_ror:8 row_mask:0xf bank_mask:0xf
    v_add_f32_dpp v33, v33, v33 row_ror:8 row_mask:0xf bank_mask:0xf
    s_mov_b64 exec, 0x00ff00ff
    v_cvt_pk_bf16_f32 v32, v32, v33
    ds_write_b32 v23, v32 offset:0
    s_mov_b64 exec, -1
    ds_read_b128 v[48:51], v21 offset:32768
    v_xor_b32 v10, 64, v21
    ds_read_b128 v[52:55], v10 offset:32768
    v_xor_b32 v10, 128, v21
    ds_read_b128 v[56:59], v10 offset:32768
    v_xor_b32 v10, 192, v21
    ds_read_b128 v[60:63], v10 offset:32768
    s_and_b32 s45, s3, 1
    s_lshl_b32 s45, s45, 4
    v_lshl_add_u32 v10, v2, 2, s45
    v_lshrrev_b32 v10, v10, v27
    v_bfe_u32 v72, v10, 0, 1
    v_lshlrev_b32 v72, 16, v72
    v_bfe_u32 v73, v10, 1, 1
    v_lshlrev_b32 v73, 16, v73
    v_bfe_u32 v74, v10, 2, 1
    v_lshlrev_b32 v74, 16, v74
    v_bfe_u32 v75, v10, 3, 1
    v_lshlrev_b32 v75, 16, v75
    v_xor_b32 v76, 0x10000, v72
    v_xor_b32 v77, 0x10000, v73
    v_xor_b32 v78, 0x10000, v74
    v_xor_b32 v79, 0x10000, v75
    v_lshlrev_b32 v10, 8, v25
    v_lshl_add_u32 v10, v2, 3, v10
    s_lshl_b32 s45, s3, 5
    v_add_u32 v10, s45, v10
    s_mov_b32 s47, 0x3e0293ee
    s_mov_b32 s53, 0xfffe0000
    s_mov_b32 s52, 0x07060302
    s_waitcnt lgkmcnt(0)
    s_barrier
    ds_read_b128 v[32:35], v24 offset:0
    ds_read_b128 v[36:39], v24 offset:64
    ds_read_b128 v[40:43], v24 offset:128
    ds_read_b128 v[44:47], v24 offset:192
    s_waitcnt lgkmcnt(2)
    v_mfma_f32_16x16x32_bf16 v[64:67], v[48:51], v[32:35], 0
    v_mfma_f32_16x16x32_bf16 v[68:71], v[52:55], v[36:39], 0
    s_waitcnt lgkmcnt(0)
    v_mfma_f32_16x16x32_bf16 v[64:67], v[56:59], v[40:43], v[64:67]
    v_mfma_f32_16x16x32_bf16 v[68:71], v[60:63], v[44:47], v[68:71]
    s_mov_b32 exec_lo, 0x00030003
    s_mov_b32 exec_hi, 0x00030003
    s_nop 5
    v_add_f32 v64, v64, v68
    v_add_f32 v65, v65, v69
    v_add_f32 v66, v66, v70
    v_add_f32 v67, v67, v71
    v_mul_f32 v64, s47, v64
    v_mul_f32 v65, s47, v65
    v_mul_f32 v66, s47, v66
    v_mul_f32 v67, s47, v67
    v_add_u32 v64, v64, v76
    v_add_u32 v65, v65, v77
    v_add_u32 v66, v66, v78
    v_add_u32 v67, v67, v79
    v_and_or_b32 v64, v64, s53, v72
    v_and_or_b32 v65, v65, s53, v73
    v_and_or_b32 v66, v66, s53, v74
    v_and_or_b32 v67, v67, s53, v75
    v_perm_b32 v64, v65, v64, s52
    v_perm_b32 v65, v67, v66, s52
    ds_write_b64 v10, v[64:65] offset:1024
    s_mov_b64 exec, -1
    s_waitcnt lgkmcnt(0)
    s_barrier
    s_cmp_lg_u32 s3, 4
    s_cbranch_scc1 .LW_noq
    ds_read_b128 v[32:35], v8 offset:1024
    v_lshlrev_b32 v36, 15, v2
    v_lshl_add_u32 v36, v3, 4, v36
    s_lshl_b32 s45, s41, 10
    s_lshl_b32 s47, s42, 8
    s_add_u32 s45, s45, s47
    s_add_u32 s45, s45, 524288
    s_mov_b32 exec_hi, 0
    s_waitcnt lgkmcnt(0)
    buffer_store_dwordx4 v[32:35], v36, s[8:11], s45 offen sc1
    s_mov_b64 exec, -1
    s_waitcnt vmcnt(0)
.LW_noq:
.LW_go:
    v_and_b32 v12, 1, v2
    v_lshlrev_b32 v12, 5, v12
    v_lshrrev_b32 v13, 1, v2
    v_lshl_add_u32 v12, v13, 4, v12
    v_lshl_add_u32 v12, v12, 13, v4
    v_xor_b32 v13, 0x80, v12
    s_and_b32 s48, s3, 3
    s_lshl_b32 s44, s42, 20
    s_lshl_b32 s45, s48, 15
    s_add_u32 s44, s44, s45
    s_lshl_b32 s45, s41, 8
    s_add_u32 s44, s44, s45
    v_lshl_add_u32 v14, v2, 10, v4
    v_xor_b32 v15, 0x80, v14
    s_lshl_b32 s43, s41, 17
    s_lshl_b32 s45, s48, 14
    s_add_u32 s43, s43, s45
    s_lshl_b32 s45, s42, 8
    s_add_u32 s43, s43, s45
    s_lshl_b32 s48, s48, 12
    s_add_u32 m0, s48, 0x10000
    s_barrier
    s_cmp_lt_u32 s3, 4
    s_cbranch_scc1 .LW_f1
    buffer_load_dwordx4 v12, s[24:27], s44 offen nt lds
    s_add_u32 m0, m0, 1024
    s_add_u32 s44, s44, 8192
    buffer_load_dwordx4 v12, s[24:27], s44 offen nt lds
    s_add_u32 m0, m0, 1024
    s_add_u32 s44, s44, 8192
    buffer_load_dwordx4 v13, s[24:27], s44 offen nt lds
    s_add_u32 m0, m0, 1024
    s_add_u32 s44, s44, 8192
    buffer_load_dwordx4 v13, s[24:27], s44 offen nt lds
    s_add_u32 m0, m0, 13312
    s_add_u32 s44, s44, 499712
    buffer_load_dwordx4 v12, s[24:27], s44 offen nt lds
    s_add_u32 m0, m0, 1024
    s_add_u32 s44, s44, 8192
    buffer_load_dwordx4 v12, s[24:27], s44 offen nt lds
    s_add_u32 m0, m0, 1024
    s_add_u32 s44, s44, 8192
    buffer_load_dwordx4 v13, s[24:27], s44 offen nt lds
    s_add_u32 m0, m0, 1024
    s_add_u32 s44, s44, 8192
    buffer_load_dwordx4 v13, s[24:27], s44 offen nt lds
    s_add_u32 m0, s48, 0x18000
    s_nop 0
    buffer_load_dwordx4 v14, s[28:31], s43 offen nt lds
    s_add_u32 m0, m0, 1024
    s_add_u32 s43, s43, 4096
    buffer_load_dwordx4 v14, s[28:31], s43 offen nt lds
    s_add_u32 m0, m0, 1024
    s_add_u32 s43, s43, 4096
    buffer_load_dwordx4 v15, s[28:31], s43 offen nt lds
    s_add_u32 m0, m0, 1024
    s_add_u32 s43, s43, 4096
    buffer_load_dwordx4 v15, s[28:31], s43 offen nt lds
    s_add_u32 m0, m0, 13312
    s_add_u32 s43, s43, 53248
    buffer_load_dwordx4 v14, s[28:31], s43 offen nt lds
    s_add_u32 m0, m0, 1024
    s_add_u32 s43, s43, 4096
    buffer_load_dwordx4 v14, s[28:31], s43 offen nt lds
    s_add_u32 m0, m0, 1024
    s_add_u32 s43, s43, 4096
    buffer_load_dwordx4 v15, s[28:31], s43 offen nt lds
    s_add_u32 m0, m0, 1024
    s_add_u32 s43, s43, 4096
    buffer_load_dwordx4 v15, s[28:31], s43 offen nt lds
    s_cmp_lg_u32 s3, 6
    s_cbranch_scc1 .LW_nowarm2
    s_lshl_b32 s45, s42, 10
    s_add_u32 s45, s45, s49
    s_add_u32 s45, s45, 131072
    buffer_load_dwordx4 v[32:35], v8, s[8:11], s45 offen sc1
.LW_nowarm2:
    s_waitcnt vmcnt(0)
    s_branch .LW_nof2
.LW_f1:
    s_cmp_eq_u32 s62, 0
    s_cbranch_scc1 .LW_nof1
    s_bitcmp1_b32 s3, 0
    s_cselect_b32 s32, s38, s36
    s_cselect_b32 s33, s39, s37
    s_mov_b32 s34, 1409024
    s_mov_b32 s35, 0x20000
    v_mul_u32_u24 v46, 22016, v2
    v_lshl_add_u32 v46, v3, 4, v46
    s_mul_i32 s48, s63, 88064
    s_lshr_b32 s44, s97, 3
    s_lshl_b32 s44, s44, 8
    s_add_u32 s48, s48, s44
    buffer_load_dwordx4 v[132:135], v46, s[32:35], s48 offen nt
    s_add_u32 s48, s48, 2752
    buffer_load_dwordx4 v[136:139], v46, s[32:35], s48 offen nt
    s_add_u32 s48, s48, 2752
    buffer_load_dwordx4 v[140:143], v46, s[32:35], s48 offen nt
    s_add_u32 s48, s48, 2752
    buffer_load_dwordx4 v[144:147], v46, s[32:35], s48 offen nt
    s_add_u32 s48, s48, 2752
    buffer_load_dwordx4 v[148:151], v46, s[32:35], s48 offen nt
    s_add_u32 s48, s48, 2752
    buffer_load_dwordx4 v[152:155], v46, s[32:35], s48 offen nt
    s_add_u32 s48, s48, 2752
    buffer_load_dwordx4 v[156:159], v46, s[32:35], s48 offen nt
    s_add_u32 s48, s48, 2752
    buffer_load_dwordx4 v[160:163], v46, s[32:35], s48 offen nt
.LW_nof1:
    s_cmp_eq_u32 s62, 0
    s_cbranch_scc1 .LW_nof2
    s_mov_b32 s52, 0x05040100
    s_mov_b32 s53, 0x07060302
    s_mov_b32 s54, 0xffff0000
    s_mov_b32 s55, 0xffff0000
    s_mov_b32 s56, 0
    s_mov_b32 s57, -1
    v_and_b32 v45, 1, v2
    v_lshlrev_b32 v44, 5, v3
    v_lshl_add_u32 v44, v45, 4, v44
    s_mov_b32 s100, 0x9E3779B1
    v_mul_lo_u32 v42, v27, s100
    v_lshrrev_b32 v41, 12, v27
    v_mov_b32 v40, v27
    v_lshrrev_b32 v43, 20, v42
    v_lshrrev_b32 v42, 8, v42
    s_movk_i32 s100, 0xfff
    v_lshrrev_b32 v45, 1, v2
    v_lshl_add_u32 v44, v45, 9, v44
    s_lshr_b32 s61, s97, 3
    s_lshl_b32 s61, s61, 15
    s_and_b32 s45, s3, 1
    s_lshl_b32 s45, s45, 14
    s_add_u32 s61, s61, s45
    s_lshl_b32 s45, s63, 10
    s_add_u32 s61, s61, s45
    s_add_u32 s61, s61, 3670016
    s_waitcnt vmcnt(0)
    v_perm_b32 v164, v136, v132, s52
    v_perm_b32 v165, v144, v140, s52
    v_perm_b32 v166, v152, v148, s52
    v_perm_b32 v167, v160, v156, s52
    v_perm_b32 v168, v136, v132, s53
    v_perm_b32 v169, v144, v140, s53
    v_perm_b32 v170, v152, v148, s53
    v_perm_b32 v171, v160, v156, s53
    v_perm_b32 v172, v137, v133, s52
    v_perm_b32 v173, v145, v141, s52
    v_perm_b32 v174, v153, v149, s52
    v_perm_b32 v175, v161, v157, s52
    v_perm_b32 v176, v137, v133, s53
    v_perm_b32 v177, v145, v141, s53
    v_perm_b32 v178, v153, v149, s53
    v_perm_b32 v179, v161, v157, s53
    v_perm_b32 v180, v138, v134, s52
    v_perm_b32 v181, v146, v142, s52
    v_perm_b32 v182, v154, v150, s52
    v_perm_b32 v183, v162, v158, s52
    v_perm_b32 v184, v138, v134, s53
    v_perm_b32 v185, v146, v142, s53
    v_perm_b32 v186, v154, v150, s53
    v_perm_b32 v187, v162, v158, s53
    v_perm_b32 v188, v139, v135, s52
    v_perm_b32 v189, v147, v143, s52
    v_perm_b32 v190, v155, v151, s52
    v_perm_b32 v191, v163, v159, s52
    v_perm_b32 v192, v139, v135, s53
    v_perm_b32 v193, v147, v143, s53
    v_perm_b32 v194, v155, v151, s53
    v_perm_b32 v195, v163, v159, s53
    s_nop 0
    v_mfma_f32_16x16x32_bf16 v[64:67], v[128:131], v[164:167], 0
    v_mfma_f32_16x16x32_bf16 v[68:71], v[128:131], v[168:171], 0
    v_mfma_f32_16x16x32_bf16 v[72:75], v[128:131], v[172:175], 0
    v_mfma_f32_16x16x32_bf16 v[76:79], v[128:131], v[176:179], 0
    v_mfma_f32_16x16x32_bf16 v[80:83], v[128:131], v[180:183], 0
    v_mfma_f32_16x16x32_bf16 v[84:87], v[128:131], v[184:187], 0
    v_mfma_f32_16x16x32_bf16 v[88:91], v[128:131], v[188:191], 0
    v_mfma_f32_16x16x32_bf16 v[92:95], v[128:131], v[192:195], 0
    s_nop 4
    v_cndmask_b32 v96, v64, v80, s[54:55]
    v_cndmask_b32 v97, v68, v84, s[54:55]
    v_cndmask_b32 v98, v72, v88, s[54:55]
    v_cndmask_b32 v99, v76, v92, s[54:55]
    v_cndmask_b32 v100, v65, v81, s[54:55]
    v_cndmask_b32 v101, v69, v85, s[54:55]
    v_cndmask_b32 v102, v73, v89, s[54:55]
    v_cndmask_b32 v103, v77, v93, s[54:55]
    v_cndmask_b32 v96, v96, v100, s[56:57]
    v_cndmask_b32 v97, v97, v101, s[56:57]
    v_cndmask_b32 v98, v98, v102, s[56:57]
    v_cndmask_b32 v99, v99, v103, s[56:57]
    v_bfi_b32 v96, s100, v40, v96
    v_bfi_b32 v97, s100, v41, v97
    v_bfi_b32 v98, s100, v42, v98
    v_bfi_b32 v99, s100, v43, v99
    buffer_store_dwordx4 v[96:99], v44, s[8:11], s61 offen sc1
    s_lshl_b32 s57, s3, 6
    s_add_u32 s57, s57, s49
.LW_nof2:
    v_lshl_add_u32 v12, v2, 8, v4
    s_add_u32 s45, s46, 0x20000
    v_add_u32 v14, s45, v12
    v_xor_b32 v15, 0x80, v14
    s_lshl_b32 s44, s50, 15
    s_add_u32 s44, s44, s46
    s_add_u32 s44, s44, 4194304
    s_mov_b32 s32, s44
    s_mov_b32 s33, s44
    s_mov_b32 s34, s44
    v_xor_b32 v13, 0x80, v12
    s_mov_b32 s46, s45
    v_bfe_u32 v10, v28, 0, 1
    v_bfe_u32 v21, v28, 1, 1
    v_lshl_or_b32 v40, v21, 16, v10
    v_bfe_u32 v10, v28, 2, 1
    v_bfe_u32 v21, v28, 3, 1
    v_lshl_or_b32 v41, v21, 16, v10
    v_bfe_u32 v10, v28, 4, 1
    v_bfe_u32 v21, v28, 5, 1
    v_lshl_or_b32 v42, v21, 16, v10
    v_bfe_u32 v10, v28, 6, 1
    v_bfe_u32 v21, v28, 7, 1
    v_lshl_or_b32 v43, v21, 16, v10
    v_mul_u32_u24 v21, 272, v25
    v_lshl_add_u32 v21, v2, 3, v21
    s_lshl_b32 s45, s3, 5
    v_add_u32 v21, s45, v21
    v_lshlrev_b32 v23, 4, v2
    v_add_u32 v10, 0x10000, v11
    v_add_u32 v11, 0x20000, v11
    s_mov_b32 s52, 0xaaaaaaaa
    s_mov_b32 s53, 0xaaaaaaaa
    s_barrier
    ds_read_b64_tr_b16 v[96:97], v10 offset:0
    ds_read_b64_tr_b16 v[98:99], v10 offset:1024
    ds_read_b64_tr_b16 v[100:101], v10 offset:8192
    ds_read_b64_tr_b16 v[102:103], v10 offset:9216
    ds_read_b64_tr_b16 v[104:105], v10 offset:16384
    ds_read_b64_tr_b16 v[106:107], v10 offset:17408
    ds_read_b64_tr_b16 v[108:109], v10 offset:24576
    ds_read_b64_tr_b16 v[110:111], v10 offset:25600
    s_lshl_b32 s45, s3, 5
    s_and_b32 s47, s3, 3
    s_lshl_b32 s47, s47, 6
    s_xor_b32 s45, s45, s47
    v_xor_b32 v10, s45, v10
    s_waitcnt lgkmcnt(4)
    ds_read_b64_tr_b16 v[112:113], v10 offset:32768
    ds_read_b64_tr_b16 v[114:115], v10 offset:33792
    ds_read_b64_tr_b16 v[116:117], v10 offset:40960
    ds_read_b64_tr_b16 v[118:119], v10 offset:41984
    ds_read_b64_tr_b16 v[120:121], v10 offset:49152
    ds_read_b64_tr_b16 v[122:123], v10 offset:50176
    ds_read_b64_tr_b16 v[124:125], v10 offset:57344
    ds_read_b64_tr_b16 v[126:127], v10 offset:58368
    s_waitcnt lgkmcnt(4)
    v_xor_b32 v10, 32, v10
    ds_read_b64_tr_b16 v[128:129], v10 offset:32768
    ds_read_b64_tr_b16 v[130:131], v10 offset:33792
    ds_read_b64_tr_b16 v[132:133], v10 offset:40960
    ds_read_b64_tr_b16 v[134:135], v10 offset:41984
    ds_read_b64_tr_b16 v[136:137], v10 offset:49152
    ds_read_b64_tr_b16 v[138:139], v10 offset:50176
    ds_read_b64_tr_b16 v[140:141], v10 offset:57344
    ds_read_b64_tr_b16 v[142:143], v10 offset:58368
    v_bfe_u32 v30, v0, 1, 1
    v_lshl_add_u32 v30, v30, 6, v16
    s_lshl_b32 s35, s42, 10
    s_add_u32 s35, s35, s49
    s_lshl_b32 s47, s47, 1
    s_add_u32 s35, s35, s47
    s_add_u32 s35, s35, 2097152
    s_mov_b32 s54, 0xcccccccc
    s_mov_b32 s55, 0xcccccccc
    s_cmp_lg_u32 s3, 0
    s_cbranch_scc1 .LW_mlw
    v_lshlrev_b32 v24, 11, v0
    s_lshl_b32 s45, s42, 9
    s_lshl_b32 s47, s41, 4
    s_add_u32 s45, s45, s47
    s_add_u32 s45, s45, 1048576
    s_add_u32 s47, s45, 131072
    s_mov_b32 s96, 4000000
    s_and_b32 s48, s2, 63
    s_lshl_b64 exec, 1, s48
.LW_ml1:
    s_sub_u32 s96, s96, 1
    s_cbranch_scc1 .LW_ml2
    s_sleep 1
    buffer_load_dwordx4 v[32:35], v24, s[8:11], s45 offen sc1
    s_waitcnt vmcnt(0)
    v_cmp_ne_u32 vcc, s40, v34
    s_cbranch_vccnz .LW_ml1
.LW_ml2:
    s_mov_b32 s96, 4000000
    s_mov_b64 s[58:59], -1
    s_mov_b64 s[60:61], -1
    s_mov_b32 s62, s40
    s_mul_i32 s63, s40, 0x9E3779B1
.LW_mlp:
    s_sub_u32 s96, s96, 1
    s_cbranch_scc1 .LW_mlx
    s_mov_b64 exec, s[58:59]
    s_cbranch_execz .LW_mls0
    buffer_load_dwordx4 v[32:35], v24, s[8:11], s45 offen sc1
.LW_mls0:
    s_mov_b64 exec, s[60:61]
    s_cbranch_execz .LW_mls1
    buffer_load_dwordx4 v[36:39], v24, s[8:11], s47 offen sc1
.LW_mls1:
    s_mov_b64 exec, -1
    s_waitcnt vmcnt(0)
    v_cmp_ne_u64 s[58:59], s[62:63], v[34:35]
    v_cmp_ne_u64 s[60:61], s[62:63], v[38:39]
    s_or_b64 vcc, s[58:59], s[60:61]
    s_cbranch_vccnz .LW_mlp
.LW_mlx:
    s_mov_b64 exec, -1
.LW_mlw:
    s_barrier
    s_mov_b32 m0, s46
    s_nop 0
    buffer_load_dwordx4 v12, s[8:11], s44 offen offset:0 sc1 lds
    buffer_load_dwordx4 v12, s[8:11], s32 offen offset:1024 sc1 lds
    buffer_load_dwordx4 v13, s[8:11], s33 offen offset:2048 sc1 lds
    buffer_load_dwordx4 v13, s[8:11], s34 offen offset:3072 sc1 lds
    s_cmp_lg_u32 s3, 0
    s_cbranch_scc1 .LW_scw
    v_mov_b32 v48, v32
    v_mov_b32 v49, v36
    s_nop 0
    v_max_f32_dpp v48, v48, v48 row_ror:8 row_mask:0xf bank_mask:0xf
    v_max_f32_dpp v49, v49, v49 row_ror:8 row_mask:0xf bank_mask:0xf
    s_nop 0
    v_max_f32_dpp v48, v48, v48 row_ror:4 row_mask:0xf bank_mask:0xf
    v_max_f32_dpp v49, v49, v49 row_ror:4 row_mask:0xf bank_mask:0xf
    s_nop 0
    v_max_f32_dpp v48, v48, v48 row_ror:2 row_mask:0xf bank_mask:0xf
    v_max_f32_dpp v49, v49, v49 row_ror:2 row_mask:0xf bank_mask:0xf
    s_nop 0
    v_max_f32_dpp v48, v48, v48 row_ror:1 row_mask:0xf bank_mask:0xf
    v_max_f32_dpp v49, v49, v49 row_ror:1 row_mask:0xf bank_mask:0xf
    v_mov_b32 v50, v48
    v_mov_b32 v51, v49
    s_nop 0
    v_permlane16_swap_b32 v48, v50
    v_permlane16_swap_b32 v49, v51
    v_max_f32 v48, v48, v50
    v_max_f32 v49, v49, v51
    v_mov_b32 v50, v48
    v_mov_b32 v51, v49
    s_nop 0
    v_permlane32_swap_b32 v48, v50
    v_permlane32_swap_b32 v49, v51
    v_max_f32 v48, v48, v50
    v_max_f32 v49, v49, v51
    v_sub_f32 v48, v32, v48
    v_sub_f32 v49, v36, v49
    v_exp_f32 v48, v48
    v_exp_f32 v49, v49
    v_lshlrev_b32 v50, 1, v0
    v_mul_f32 v52, v48, v33
    v_mul_f32 v53, v49, v37
    s_nop 0
    v_add_f32_dpp v52, v52, v52 row_ror:8 row_mask:0xf bank_mask:0xf
    v_add_f32_dpp v53, v53, v53 row_ror:8 row_mask:0xf bank_mask:0xf
    s_nop 0
    v_add_f32_dpp v52, v52, v52 row_ror:4 row_mask:0xf bank_mask:0xf
    v_add_f32_dpp v53, v53, v53 row_ror:4 row_mask:0xf bank_mask:0xf
    s_nop 0
    v_add_f32_dpp v52, v52, v52 row_ror:2 row_mask:0xf bank_mask:0xf
    v_add_f32_dpp v53, v53, v53 row_ror:2 row_mask:0xf bank_mask:0xf
    s_nop 0
    v_add_f32_dpp v52, v52, v52 row_ror:1 row_mask:0xf bank_mask:0xf
    v_add_f32_dpp v53, v53, v53 row_ror:1 row_mask:0xf bank_mask:0xf
    v_mov_b32 v54, v52
    v_mov_b32 v55, v53
    s_nop 0
    v_permlane16_swap_b32 v52, v54
    v_permlane16_swap_b32 v53, v55
    v_add_f32 v52, v52, v54
    v_add_f32 v53, v53, v55
    v_mov_b32 v54, v52
    v_mov_b32 v55, v53
    s_nop 0
    v_permlane32_swap_b32 v52, v54
    v_permlane32_swap_b32 v53, v55
    v_add_f32 v52, v52, v54
    v_add_f32 v53, v53, v55
    v_rcp_f32 v52, v52
    v_rcp_f32 v53, v53
    s_nop 0
    v_mul_f32 v48, v48, v52
    v_mul_f32 v49, v49, v53
    v_cvt_pk_bf16_f32 v48, v48, v49
    ds_write_b16 v50, v48 offset:2048
    ds_write_b16_d16_hi v50, v48 offset:2176
.LW_scw:
    s_mov_b32 s96, 4000000
.LW_pv:
    s_waitcnt vmcnt(0)
    ds_read_b128 v[64:67], v14 offset:0
    ds_read_b128 v[68:71], v14 offset:1024
    ds_read_b128 v[72:75], v15 offset:2048
    ds_read_b128 v[76:79], v15 offset:3072
    s_waitcnt lgkmcnt(3)
    v_xor_b32 v44, v64, v40
    v_bitop3_b32 v44, v44, v65, v41 bitop3:0xf6
    v_bitop3_b32 v44, v44, v66, v42 bitop3:0xf6
    v_bitop3_b32 v44, v44, v67, v43 bitop3:0xf6
    s_waitcnt lgkmcnt(2)
    v_xor_b32 v45, v68, v40
    v_bitop3_b32 v45, v45, v69, v41 bitop3:0xf6
    v_bitop3_b32 v45, v45, v70, v42 bitop3:0xf6
    v_bitop3_b32 v45, v45, v71, v43 bitop3:0xf6
    s_waitcnt lgkmcnt(1)
    v_xor_b32 v46, v72, v40
    v_bitop3_b32 v46, v46, v73, v41 bitop3:0xf6
    v_bitop3_b32 v46, v46, v74, v42 bitop3:0xf6
    v_bitop3_b32 v46, v46, v75, v43 bitop3:0xf6
    s_waitcnt lgkmcnt(0)
    v_xor_b32 v47, v76, v40
    v_bitop3_b32 v47, v47, v77, v41 bitop3:0xf6
    v_bitop3_b32 v47, v47, v78, v42 bitop3:0xf6
    v_bitop3_b32 v47, v47, v79, v43 bitop3:0xf6
    v_or3_b32 v39, v44, v45, v46
    v_or_b32 v39, v39, v47
    v_and_b32 v39, 0x10001, v39
    v_cmp_ne_u32 vcc, 0, v39
    s_cbranch_vccz .LW_pk
    s_sub_u32 s96, s96, 1
    s_cbranch_scc1 .LW_pk
    v_and_b32 v44, 0x10001, v44
    v_cmp_ne_u32 vcc, 0, v44
    s_cbranch_vccz .LW_pr0
    buffer_load_dwordx4 v12, s[8:11], s44 offen offset:0 sc1 lds
.LW_pr0:
    v_and_b32 v45, 0x10001, v45
    v_cmp_ne_u32 vcc, 0, v45
    s_cbranch_vccz .LW_pr1
    buffer_load_dwordx4 v12, s[8:11], s32 offen offset:1024 sc1 lds
.LW_pr1:
    v_and_b32 v46, 0x10001, v46
    v_cmp_ne_u32 vcc, 0, v46
    s_cbranch_vccz .LW_pr2
    buffer_load_dwordx4 v13, s[8:11], s33 offen offset:2048 sc1 lds
.LW_pr2:
    v_and_b32 v47, 0x10001, v47
    v_cmp_ne_u32 vcc, 0, v47
    s_cbranch_vccz .LW_pr3
    buffer_load_dwordx4 v13, s[8:11], s34 offen offset:3072 sc1 lds
.LW_pr3:
    s_branch .LW_pv
.LW_pk:
    s_barrier
    ds_read_b128 v[48:51], v23 offset:2048
    ds_read_b64_tr_b16 v[64:65], v11 offset:0
    ds_read_b64_tr_b16 v[66:67], v11 offset:1024
    ds_read_b128 v[52:55], v23 offset:2112
    ds_read_b64_tr_b16 v[68:69], v11 offset:8192
    ds_read_b64_tr_b16 v[70:71], v11 offset:9216
    ds_read_b128 v[56:59], v23 offset:2176
    ds_read_b64_tr_b16 v[72:73], v11 offset:16384
    ds_read_b64_tr_b16 v[74:75], v11 offset:17408
    ds_read_b128 v[60:63], v23 offset:2240
    ds_read_b64_tr_b16 v[76:77], v11 offset:24576
    ds_read_b64_tr_b16 v[78:79], v11 offset:25600
    s_waitcnt lgkmcnt(9)
    v_mfma_f32_16x16x32_bf16 v[80:83], v[64:67], v[48:51], 0
    s_waitcnt lgkmcnt(3)
    v_mfma_f32_16x16x32_bf16 v[84:87], v[72:75], v[56:59], 0
    v_mfma_f32_16x16x32_bf16 v[80:83], v[68:71], v[52:55], v[80:83]
    s_waitcnt lgkmcnt(0)
    v_mfma_f32_16x16x32_bf16 v[84:87], v[76:79], v[60:63], v[84:87]
    s_mov_b32 exec_lo, 0x00030003
    s_mov_b32 exec_hi, 0x00030003
    s_nop 5
    v_cndmask_b32 v80, v80, v84, s[52:53]
    v_cndmask_b32 v81, v81, v85, s[52:53]
    v_cndmask_b32 v82, v82, v86, s[52:53]
    v_cndmask_b32 v83, v83, v87, s[52:53]
    v_cvt_pk_bf16_f32 v80, v80, v81
    v_cvt_pk_bf16_f32 v81, v82, v83
    ds_write_b64 v21, v[80:81] offset:2560
    s_mov_b64 exec, -1
    s_waitcnt lgkmcnt(0)
    s_barrier
    ds_read_b128 v[48:51], v26 offset:2560
    ds_read_b128 v[52:55], v26 offset:2624
    ds_read_b128 v[56:59], v26 offset:2688
    ds_read_b128 v[60:63], v26 offset:2752
    s_waitcnt lgkmcnt(2)
    v_mfma_f32_16x16x32_bf16 v[80:83], v[96:99], v[48:51], 0
    v_mfma_f32_16x16x32_bf16 v[84:87], v[100:103], v[52:55], 0
    s_waitcnt lgkmcnt(0)
    v_mfma_f32_16x16x32_bf16 v[80:83], v[104:107], v[56:59], v[80:83]
    v_mfma_f32_16x16x32_bf16 v[84:87], v[108:111], v[60:63], v[84:87]
    s_add_u32 s45, s51, 131072
    s_add_u32 s47, s57, 131072
    s_mov_b32 s96, 4000000
    v_mov_b32 v204, v200
    v_mov_b32 v205, v201
    v_mov_b32 v206, v202
    v_mov_b32 v207, v203
    s_nop 0
    v_add_f32 v80, v80, v84
    v_add_f32 v81, v81, v85
    v_add_f32 v82, v82, v86
    v_add_f32 v83, v83, v87
    s_mov_b32 exec_lo, 0x00030003
    s_mov_b32 exec_hi, 0x00030003
    v_bfi_b32 v84, s100, v200, v80
    v_bfi_b32 v85, s100, v201, v81
    v_bfi_b32 v86, s100, v202, v82
    v_bfi_b32 v87, s100, v203, v83
    buffer_store_dwordx4 v[84:87], v16, s[8:11], s45 offen
    s_mov_b64 exec, -1
    ds_bpermute_b32 v40, v29, v80
    ds_bpermute_b32 v41, v29, v81
    ds_bpermute_b32 v42, v29, v82
    ds_bpermute_b32 v43, v29, v83
    s_mov_b64 exec, s[98:99]
.LW_h4_p:
    buffer_load_dwordx4 v[32:35], v1, s[8:11], s47 offen sc1
    s_waitcnt vmcnt(0)
    v_xor_b32 v36, v32, v204
    v_bitop3_b32 v36, v36, v33, v205 bitop3:0xf6
    v_bitop3_b32 v36, v36, v34, v206 bitop3:0xf6
    v_bitop3_b32 v36, v36, v35, v207 bitop3:0xf6
    v_and_b32 v36, 0xfff, v36
    v_cmp_ne_u32 vcc, 0, v36
    s_cbranch_vccz .LW_h4_g
    s_sub_u32 s96, s96, 1
    s_cbranch_scc1 .LW_h4_g
    s_sleep 1
    s_cmp_gt_u32 s96, 3999986
    s_cbranch_scc1 .LW_h4_p
    s_xor_b32 s47, s47, 262144
    v_xor_b32 v204, s101, v204
    v_xor_b32 v205, s101, v205
    v_xor_b32 v206, s101, v206
    v_xor_b32 v207, s101, v207
    s_cmp_lg_u32 s96, 3999986
    s_cbranch_scc1 .LW_h4_p
    s_add_u32 s45, s51, 393216
    s_mov_b32 exec_lo, 0x00030003
    s_mov_b32 exec_hi, 0x00030003
    v_bfi_b32 v84, s100, v17, v80
    v_bfi_b32 v85, s100, v18, v81
    v_bfi_b32 v86, s100, v19, v82
    v_bfi_b32 v87, s100, v20, v83
    buffer_store_dwordx4 v[84:87], v16, s[8:11], s45 offen sc1
    s_mov_b64 exec, -1
    s_mov_b64 exec, s[98:99]
    s_branch .LW_h4_p
.LW_h4_g:
    s_mov_b64 exec, -1
    s_waitcnt lgkmcnt(0)
    v_cndmask_b32 v32, v40, v32, s[98:99]
    v_cndmask_b32 v33, v41, v33, s[98:99]
    v_cndmask_b32 v34, v42, v34, s[98:99]
    v_cndmask_b32 v35, v43, v35, s[98:99]
    s_nop 0
    v_permlane16_swap_b32 v32, v34
    v_permlane16_swap_b32 v33, v35
    v_add_f32 v32, v32, v34
    v_add_f32 v33, v33, v35
    s_nop 1
    v_add_f32_dpp v32, v32, v32 row_ror:8 row_mask:0xf bank_mask:0xf
    v_add_f32_dpp v33, v33, v33 row_ror:8 row_mask:0xf bank_mask:0xf
    s_mov_b64 exec, 0x00ff00ff
    v_cvt_pk_bf16_f32 v32, v32, v33
    ds_write_b32 v22, v32 offset:3200
    s_mov_b64 exec, -1
    s_waitcnt lgkmcnt(0)
    s_add_u32 s45, s51, 2097152
    s_barrier
    s_cmp_gt_u32 s3, 3
    s_cbranch_scc1 .LW_end
    ds_read_b128 v[48:51], v26 offset:3200
    ds_read_b128 v[52:55], v26 offset:3264
    ds_read_b128 v[56:59], v26 offset:3328
    ds_read_b128 v[60:63], v26 offset:3392
    s_waitcnt lgkmcnt(3)
    v_mfma_f32_16x16x32_bf16 v[64:67], v[112:115], v[48:51], 0
    v_mfma_f32_16x16x32_bf16 v[68:71], v[128:131], v[48:51], 0
    s_waitcnt lgkmcnt(2)
    v_mfma_f32_16x16x32_bf16 v[64:67], v[116:119], v[52:55], v[64:67]
    v_mfma_f32_16x16x32_bf16 v[68:71], v[132:135], v[52:55], v[68:71]
    s_waitcnt lgkmcnt(1)
    v_mfma_f32_16x16x32_bf16 v[64:67], v[120:123], v[56:59], v[64:67]
    v_mfma_f32_16x16x32_bf16 v[68:71], v[136:139], v[56:59], v[68:71]
    s_waitcnt lgkmcnt(0)
    v_mfma_f32_16x16x32_bf16 v[64:67], v[124:127], v[60:63], v[64:67]
    v_mfma_f32_16x16x32_bf16 v[68:71], v[140:143], v[60:63], v[68:71]
    s_mov_b32 exec_lo, 0x000f000f
    s_mov_b32 exec_hi, 0x000f000f
    s_nop 5
    v_cndmask_b32 v64, v64, v68, s[54:55]
    v_cndmask_b32 v65, v65, v69, s[54:55]
    v_cndmask_b32 v66, v66, v70, s[54:55]
    v_cndmask_b32 v67, v67, v71, s[54:55]
    v_bfi_b32 v64, s100, v17, v64
    v_bfi_b32 v65, s100, v18, v65
    v_bfi_b32 v66, s100, v19, v66
    v_bfi_b32 v67, s100, v20, v67
    buffer_store_dwordx4 v[64:67], v30, s[8:11], s35 offen sc1
.LW_end:
    s_endpgm
.L_A:
    s_cmp_ge_u32 s2, 256
    s_cbranch_scc1 .L_end
    s_load_dwordx2 s[16:17], s[0:1], 8
    s_load_dwordx2 s[4:5], s[0:1], 0
    s_load_dwordx4 s[36:39], s[0:1], 56
    s_load_dwordx2 s[12:13], s[0:1], 88
    s_load_dwordx2 s[8:9], s[0:1], 96
    s_load_dwordx2 s[28:29], s[0:1], 72
    s_load_dwordx2 s[32:33], s[0:1], 80
    v_lshrrev_b32 v1, 6, v0
    v_and_b32 v0, 63, v0
    v_readfirstlane_b32 s3, v1
    s_sub_u32 s43, s2, 128
    s_bfe_u32 s41, s43, 0x10002
    s_lshr_b32 s42, s43, 3
    s_lshl_b32 s42, s42, 2
    s_and_b32 s44, s43, 3
    s_add_u32 s42, s42, s44
    s_lshl_b32 s44, s41, 6
    s_add_u32 s42, s42, s44
    s_mov_b32 s18, 16777216
    s_mov_b32 s19, 0x20000
    s_mov_b32 s14, 256
    s_mov_b32 s15, 0x20000
    s_mov_b32 s10, 268435456
    s_mov_b32 s11, 0x20000
    s_mov_b32 s6, 2048
    s_mov_b32 s7, 0x20000
    s_mov_b32 s30, 1409024
    s_mov_b32 s31, 0x20000
    s_mov_b32 s34, 2048
    s_mov_b32 s35, 0x20000
    v_lshlrev_b32 v8, 4, v0
    v_mov_b32 v9, 0
    v_lshrrev_b32 v2, 4, v0
    v_and_b32 v3, 15, v0
    v_and_b32 v25, 1, v0
    s_and_b32 s47, s3, 3
    s_cmp_lt_u32 s3, 4
    s_cbranch_scc1 .LA_comp
    s_lshl_b32 s46, s47, 13
    s_lshl_b32 s44, s42, 17
    s_lshl_b32 s45, s47, 15
    s_add_u32 s44, s44, s45
    v_lshlrev_b32 v4, 2, v2
    v_xor_b32 v4, v4, v3
    v_lshlrev_b32 v4, 4, v4
    v_lshl_add_u32 v4, v2, 10, v4
    v_xor_b32 v5, 16, v4
    v_xor_b32 v6, 32, v4
    v_xor_b32 v7, 48, v4
    s_mov_b32 m0, s46
    s_waitcnt lgkmcnt(0)
    buffer_load_dword v12, v9, s[4:7], 0 offen
    s_add_u32 s60, s46, 131072
    s_lshl_b32 s63, s41, 15
    s_add_u32 s63, s63, s46
    s_add_u32 s63, s63, 524288
    s_and_b32 s45, s47, 1
    s_lshl_b32 s45, s45, 5
    v_xor_b32 v24, s45, v8
    v_add_u32 v58, s60, v24
    s_waitcnt vmcnt(0)
    buffer_load_dwordx4 v4, s[16:19], s44 offen nt lds
    s_add_u32 m0, m0, 32768
    s_add_u32 s44, s44, 256
    buffer_load_dwordx4 v4, s[16:19], s44 offen nt lds
    s_add_u32 m0, m0, 32768
    s_add_u32 s44, s44, 256
    buffer_load_dwordx4 v4, s[16:19], s44 offen nt lds
    s_add_u32 m0, m0, 32768
    s_add_u32 s44, s44, 256
    buffer_load_dwordx4 v4, s[16:19], s44 offen nt lds
    buffer_load_dword v11, v9, s[12:15], 0 offen offset:128 sc1
    s_waitcnt vmcnt(3)
    s_sub_u32 m0, m0, 97280
    s_add_u32 s44, s44, 3328
    buffer_load_dwordx4 v5, s[16:19], s44 offen nt lds
    s_waitcnt vmcnt(3)
    s_add_u32 m0, m0, 32768
    s_add_u32 s44, s44, 256
    buffer_load_dwordx4 v5, s[16:19], s44 offen nt lds
    s_waitcnt vmcnt(3)
    s_add_u32 m0, m0, 32768
    s_add_u32 s44, s44, 256
    buffer_load_dwordx4 v5, s[16:19], s44 offen nt lds
    s_waitcnt vmcnt(3)
    s_add_u32 m0, m0, 32768
    s_add_u32 s44, s44, 256
    buffer_load_dwordx4 v5, s[16:19], s44 offen nt lds
    s_sub_u32 m0, m0, 97280
    s_add_u32 s44, s44, 3328
    buffer_load_dwordx4 v6, s[16:19], s44 offen nt lds
    s_add_u32 m0, m0, 32768
    s_add_u32 s44, s44, 256
    buffer_load_dwordx4 v6, s[16:19], s44 offen nt lds
    s_add_u32 m0, m0, 32768
    s_add_u32 s44, s44, 256
    buffer_load_dwordx4 v6, s[16:19], s44 offen nt lds
    s_add_u32 m0, m0, 32768
    s_add_u32 s44, s44, 256
    buffer_load_dwordx4 v6, s[16:19], s44 offen nt lds
    s_waitcnt vmcnt(11)
    s_sub_u32 m0, m0, 97280
    s_add_u32 s44, s44, 3328
    buffer_load_dwordx4 v7, s[16:19], s44 offen nt lds
    s_waitcnt vmcnt(11)
    s_add_u32 m0, m0, 32768
    s_add_u32 s44, s44, 256
    buffer_load_dwordx4 v7, s[16:19], s44 offen nt lds
    s_waitcnt vmcnt(10)
    s_mov_b32 s96, 4000000
.LH_nchk:
    v_readfirstlane_b32 s40, v11
    s_cmp_lg_u32 s40, 0
    s_cbranch_scc1 .LH_ngot
    s_sub_u32 s96, s96, 1
    s_cbranch_scc1 .LH_ngot
    buffer_load_dword v11, v9, s[12:15], 0 offen offset:128 sc1
    s_waitcnt vmcnt(0)
    s_branch .LH_nchk
.LH_ngot:
    s_waitcnt vmcnt(11)
    s_add_u32 m0, m0, 32768
    s_add_u32 s44, s44, 256
    buffer_load_dwordx4 v7, s[16:19], s44 offen nt lds
    s_waitcnt vmcnt(11)
    s_add_u32 m0, m0, 32768
    s_add_u32 s44, s44, 256
    buffer_load_dwordx4 v7, s[16:19], s44 offen nt lds
    s_waitcnt vmcnt(11)
    s_sub_u32 m0, m0, 97280
    s_add_u32 s44, s44, 3328
    buffer_load_dwordx4 v4, s[16:19], s44 offen nt lds
    s_waitcnt vmcnt(11)
    s_add_u32 m0, m0, 32768
    s_add_u32 s44, s44, 256
    buffer_load_dwordx4 v4, s[16:19], s44 offen nt lds
    s_waitcnt vmcnt(11)
    s_add_u32 m0, m0, 32768
    s_add_u32 s44, s44, 256
    buffer_load_dwordx4 v4, s[16:19], s44 offen nt lds
    s_waitcnt vmcnt(11)
    s_add_u32 m0, m0, 32768
    s_add_u32 s44, s44, 256
    buffer_load_dwordx4 v4, s[16:19], s44 offen nt lds
    s_waitcnt vmcnt(11)
    s_sub_u32 m0, m0, 97280
    s_add_u32 s44, s44, 3328
    buffer_load_dwordx4 v5, s[16:19], s44 offen nt lds
    s_waitcnt vmcnt(11)
    s_add_u32 m0, m0, 32768
    s_add_u32 s44, s44, 256
    buffer_load_dwordx4 v5, s[16:19], s44 offen nt lds
    s_waitcnt vmcnt(11)
    s_add_u32 m0, m0, 32768
    s_add_u32 s44, s44, 256
    buffer_load_dwordx4 v5, s[16:19], s44 offen nt lds
    s_waitcnt vmcnt(11)
    s_add_u32 m0, m0, 32768
    s_add_u32 s44, s44, 256
    buffer_load_dwordx4 v5, s[16:19], s44 offen nt lds
    s_waitcnt vmcnt(11)
    s_sub_u32 m0, m0, 97280
    s_add_u32 s44, s44, 3328
    buffer_load_dwordx4 v6, s[16:19], s44 offen nt lds
    s_waitcnt vmcnt(11)
    s_add_u32 m0, m0, 32768
    s_add_u32 s44, s44, 256
    buffer_load_dwordx4 v6, s[16:19], s44 offen nt lds
    s_waitcnt vmcnt(11)
    s_add_u32 m0, m0, 32768
    s_add_u32 s44, s44, 256
    buffer_load_dwordx4 v6, s[16:19], s44 offen nt lds
    s_waitcnt vmcnt(11)
    s_add_u32 m0, m0, 32768
    s_add_u32 s44, s44, 256
    buffer_load_dwordx4 v6, s[16:19], s44 offen nt lds
    s_waitcnt vmcnt(11)
    s_sub_u32 m0, m0, 97280
    s_add_u32 s44, s44, 3328
    buffer_load_dwordx4 v7, s[16:19], s44 offen nt lds
    s_waitcnt vmcnt(11)
    s_add_u32 m0, m0, 32768
    s_add_u32 s44, s44, 256
    buffer_load_dwordx4 v7, s[16:19], s44 offen nt lds
    s_waitcnt vmcnt(11)
    s_add_u32 m0, m0, 32768
    s_add_u32 s44, s44, 256
    buffer_load_dwordx4 v7, s[16:19], s44 offen nt lds
    s_waitcnt vmcnt(11)
    s_add_u32 m0, m0, 32768
    s_add_u32 s44, s44, 256
    buffer_load_dwordx4 v7, s[16:19], s44 offen nt lds
    s_waitcnt vmcnt(1)
    s_mov_b32 s61, m0
    s_mov_b32 m0, s60
    s_mov_b32 s45, s63
    v_xor_b32 v10, 0, v24
    buffer_load_dwordx4 v10, s[8:11], s45 offen offset:0 sc1 lds
    v_xor_b32 v10, 64, v24
    buffer_load_dwordx4 v10, s[8:11], s45 offen offset:1024 sc1 lds
    v_xor_b32 v10, 128, v24
    buffer_load_dwordx4 v10, s[8:11], s45 offen offset:2048 sc1 lds
    v_xor_b32 v10, 192, v24
    buffer_load_dwordx4 v10, s[8:11], s45 offen offset:3072 sc1 lds
    s_add_u32 m0, m0, 4096
    s_add_u32 s45, s45, 4096
    v_xor_b32 v10, 16, v24
    buffer_load_dwordx4 v10, s[8:11], s45 offen offset:0 sc1 lds
    v_xor_b32 v10, 80, v24
    buffer_load_dwordx4 v10, s[8:11], s45 offen offset:1024 sc1 lds
    v_xor_b32 v10, 144, v24
    buffer_load_dwordx4 v10, s[8:11], s45 offen offset:2048 sc1 lds
    v_xor_b32 v10, 208, v24
    buffer_load_dwordx4 v10, s[8:11], s45 offen offset:3072 sc1 lds
    s_mov_b32 m0, s61
    v_lshrrev_b32 v7, 5, v0
    v_bfe_u32 v4, v0, 2, 2
    v_lshlrev_b32 v5, 10, v7
    v_lshl_add_u32 v5, v4, 8, v5
    v_lshl_add_u32 v5, v4, 6, v5
    v_bfe_u32 v6, v0, 4, 1
    v_bfe_u32 v4, v0, 1, 1
    v_lshl_add_u32 v6, v6, 1, v4
    v_xor_b32 v6, v6, v7
    v_lshl_add_u32 v5, v6, 4, v5
    v_lshl_add_u32 v5, v25, 3, v5
    s_lshr_b32 s45, s3, 2
    s_lshl_b32 s45, s45, 7
    v_xor_b32 v5, s45, v5
    s_lshl_b32 s44, s47, 15
    v_add_u32 v32, s44, v5
    v_mov_b32 v54, 0
    v_xor_b32 v33, 32, v32
    v_xor_b32 v34, 64, v32
    v_xor_b32 v35, 96, v32
    v_add_u32 v51, 133120, v8
    v_bfe_u32 v4, v0, 4, 1
    v_lshl_add_u32 v5, v7, 2, v4
    v_lshlrev_b32 v36, 17, v5
    v_lshl_add_u32 v36, v3, 3, v36
    v_mov_b32 v37, v36
    v_mov_b32 v38, v36
    v_mov_b32 v39, v36
    s_add_u32 s44, s44, s45
    s_lshl_b32 s45, s42, 8
    s_add_u32 s44, s44, s45
    s_add_u32 s44, s44, 4194304
    s_add_u32 s48, s44, 0
    s_add_u32 s49, s44, 262144
    s_add_u32 s50, s44, 1048576
    s_add_u32 s51, s44, 1310720
    s_add_u32 s52, s44, 2097152
    s_add_u32 s53, s44, 2359296
    s_add_u32 s54, s44, 3145728
    s_add_u32 s55, s44, 3407872
    v_and_b32 v5, 7, v0
    v_lshl_add_u32 v4, v5, 1, v4
    v_lshlrev_b32 v4, 1, v4
    v_lshrrev_b32 v4, v4, v11
    v_and_b32 v5, 1, v4
    v_bfe_u32 v4, v4, 1, 1
    v_lshl_or_b32 v53, v4, 16, v5
    s_mov_b32 s56, 0x00010001
    v_and_b32 v10, 3, v0
    v_lshlrev_b32 v10, 3, v10
    v_lshrrev_b32 v12, v10, v11
    v_bfe_u32 v56, v12, 0, 1
    v_bfe_u32 v57, v12, 1, 1
    v_lshl_or_b32 v60, v57, 16, v56
    v_bfe_u32 v56, v12, 2, 1
    v_bfe_u32 v57, v12, 3, 1
    v_lshl_or_b32 v61, v57, 16, v56
    v_bfe_u32 v56, v12, 4, 1
    v_bfe_u32 v57, v12, 5, 1
    v_lshl_or_b32 v62, v57, 16, v56
    v_bfe_u32 v56, v12, 6, 1
    v_bfe_u32 v57, v12, 7, 1
    v_lshl_or_b32 v63, v57, 16, v56
    v_lshlrev_b32 v5, 13, v2
    v_lshl_add_u32 v5, v3, 4, v5
    s_sub_u32 s62, s43, 85
    s_lshl_b32 s46, s62, 15
    s_lshl_b32 s45, s47, 8
    s_add_u32 s46, s46, s45
    s_waitcnt vmcnt(8)
    s_mov_b32 s96, 4000000
.LH_qv:
    s_waitcnt vmcnt(0)
    v_xor_b32 v10, 0, v58
    ds_read_b128 v[64:67], v10 offset:0
    v_xor_b32 v10, 64, v58
    ds_read_b128 v[68:71], v10 offset:1024
    v_xor_b32 v10, 128, v58
    ds_read_b128 v[72:75], v10 offset:2048
    v_xor_b32 v10, 192, v58
    ds_read_b128 v[76:79], v10 offset:3072
    v_xor_b32 v10, 16, v58
    ds_read_b128 v[80:83], v10 offset:4096
    v_xor_b32 v10, 80, v58
    ds_read_b128 v[84:87], v10 offset:5120
    v_xor_b32 v10, 144, v58
    ds_read_b128 v[88:91], v10 offset:6144
    v_xor_b32 v10, 208, v58
    ds_read_b128 v[92:95], v10 offset:7168
    s_waitcnt lgkmcnt(7)
    v_xor_b32 v56, v64, v60
    v_bitop3_b32 v56, v56, v65, v61 bitop3:0xf6
    v_bitop3_b32 v56, v56, v66, v62 bitop3:0xf6
    v_bitop3_b32 v56, v56, v67, v63 bitop3:0xf6
    s_waitcnt lgkmcnt(6)
    v_bitop3_b32 v56, v56, v68, v60 bitop3:0xf6
    v_bitop3_b32 v56, v56, v69, v61 bitop3:0xf6
    v_bitop3_b32 v56, v56, v70, v62 bitop3:0xf6
    v_bitop3_b32 v56, v56, v71, v63 bitop3:0xf6
    s_waitcnt lgkmcnt(5)
    v_bitop3_b32 v56, v56, v72, v60 bitop3:0xf6
    v_bitop3_b32 v56, v56, v73, v61 bitop3:0xf6
    v_bitop3_b32 v56, v56, v74, v62 bitop3:0xf6
    v_bitop3_b32 v56, v56, v75, v63 bitop3:0xf6
    s_waitcnt lgkmcnt(4)
    v_bitop3_b32 v56, v56, v76, v60 bitop3:0xf6
    v_bitop3_b32 v56, v56, v77, v61 bitop3:0xf6
    v_bitop3_b32 v56, v56, v78, v62 bitop3:0xf6
    v_bitop3_b32 v56, v56, v79, v63 bitop3:0xf6
    s_waitcnt lgkmcnt(3)
    v_bitop3_b32 v56, v56, v80, v60 bitop3:0xf6
    v_bitop3_b32 v56, v56, v81, v61 bitop3:0xf6
    v_bitop3_b32 v56, v56, v82, v62 bitop3:0xf6
    v_bitop3_b32 v56, v56, v83, v63 bitop3:0xf6
    s_waitcnt lgkmcnt(2)
    v_bitop3_b32 v56, v56, v84, v60 bitop3:0xf6
    v_bitop3_b32 v56, v56, v85, v61 bitop3:0xf6
    v_bitop3_b32 v56, v56, v86, v62 bitop3:0xf6
    v_bitop3_b32 v56, v56, v87, v63 bitop3:0xf6
    s_waitcnt lgkmcnt(1)
    v_bitop3_b32 v56, v56, v88, v60 bitop3:0xf6
    v_bitop3_b32 v56, v56, v89, v61 bitop3:0xf6
    v_bitop3_b32 v56, v56, v90, v62 bitop3:0xf6
    v_bitop3_b32 v56, v56, v91, v63 bitop3:0xf6
    s_waitcnt lgkmcnt(0)
    v_bitop3_b32 v56, v56, v92, v60 bitop3:0xf6
    v_bitop3_b32 v56, v56, v93, v61 bitop3:0xf6
    v_bitop3_b32 v56, v56, v94, v62 bitop3:0xf6
    v_bitop3_b32 v56, v56, v95, v63 bitop3:0xf6
    v_and_b32 v56, s56, v56
    v_cmp_ne_u32 vcc, 0, v56
    s_cbranch_vccz .LH_qk
    s_sub_u32 s96, s96, 1
    s_cbranch_scc1 .LH_qk
    s_mov_b32 s61, m0
    s_mov_b32 m0, s60
    s_mov_b32 s45, s63
    v_xor_b32 v10, 0, v24
    buffer_load_dwordx4 v10, s[8:11], s45 offen offset:0 sc1 lds
    v_xor_b32 v10, 64, v24
    buffer_load_dwordx4 v10, s[8:11], s45 offen offset:1024 sc1 lds
    v_xor_b32 v10, 128, v24
    buffer_load_dwordx4 v10, s[8:11], s45 offen offset:2048 sc1 lds
    v_xor_b32 v10, 192, v24
    buffer_load_dwordx4 v10, s[8:11], s45 offen offset:3072 sc1 lds
    s_add_u32 m0, m0, 4096
    s_add_u32 s45, s45, 4096
    v_xor_b32 v10, 16, v24
    buffer_load_dwordx4 v10, s[8:11], s45 offen offset:0 sc1 lds
    v_xor_b32 v10, 80, v24
    buffer_load_dwordx4 v10, s[8:11], s45 offen offset:1024 sc1 lds
    v_xor_b32 v10, 144, v24
    buffer_load_dwordx4 v10, s[8:11], s45 offen offset:2048 sc1 lds
    v_xor_b32 v10, 208, v24
    buffer_load_dwordx4 v10, s[8:11], s45 offen offset:3072 sc1 lds
    s_mov_b32 m0, s61
    s_branch .LH_qv
.LH_qk:
    s_barrier
    s_cmp_lt_u32 s43, 85
    s_cbranch_scc1 .LH_now2
    buffer_load_dwordx4 v[208:211], v5, s[28:31], s46 offen offset:0 nt
    buffer_load_dwordx4 v[212:215], v5, s[28:31], s46 offen offset:1024 nt
    buffer_load_dwordx4 v[216:219], v5, s[28:31], s46 offen offset:2048 nt
    buffer_load_dwordx4 v[220:223], v5, s[28:31], s46 offen offset:3072 nt
    s_add_u32 s46, s46, 4096
    buffer_load_dwordx4 v[224:227], v5, s[28:31], s46 offen offset:0 nt
    buffer_load_dwordx4 v[228:231], v5, s[28:31], s46 offen offset:1024 nt
    buffer_load_dwordx4 v[232:235], v5, s[28:31], s46 offen offset:2048 nt
    buffer_load_dwordx4 v[236:239], v5, s[28:31], s46 offen offset:3072 nt
.LH_now2:
    s_barrier
    ds_read_b64_tr_b16 v[96:97], v32 offset:0
    ds_read_b64_tr_b16 v[98:99], v33 offset:2048
    ds_read_b64_tr_b16 v[100:101], v34 offset:0
    ds_read_b64_tr_b16 v[102:103], v35 offset:2048
    ds_read_b64_tr_b16 v[104:105], v32 offset:4096
    ds_read_b64_tr_b16 v[106:107], v33 offset:6144
    ds_read_b64_tr_b16 v[108:109], v34 offset:4096
    ds_read_b64_tr_b16 v[110:111], v35 offset:6144
    ds_read_b64_tr_b16 v[112:113], v32 offset:8192
    ds_read_b64_tr_b16 v[114:115], v33 offset:10240
    ds_read_b64_tr_b16 v[116:117], v34 offset:8192
    ds_read_b64_tr_b16 v[118:119], v35 offset:10240
    ds_read_b64_tr_b16 v[120:121], v32 offset:12288
    ds_read_b64_tr_b16 v[122:123], v33 offset:14336
    s_waitcnt lgkmcnt(12)
    ds_read_b64_tr_b16 v[124:125], v34 offset:12288
    ds_read_b64_tr_b16 v[126:127], v35 offset:14336
    s_barrier
    s_waitcnt lgkmcnt(12)
    ds_read_b64_tr_b16 v[128:129], v32 offset:16384
    ds_read_b64_tr_b16 v[130:131], v33 offset:18432
    s_waitcnt lgkmcnt(12)
    ds_read_b64_tr_b16 v[132:133], v34 offset:16384
    ds_read_b64_tr_b16 v[134:135], v35 offset:18432
    s_waitcnt lgkmcnt(12)
    ds_read_b64_tr_b16 v[136:137], v32 offset:20480
    ds_read_b64_tr_b16 v[138:139], v33 offset:22528
    s_waitcnt lgkmcnt(12)
    ds_read_b64_tr_b16 v[140:141], v34 offset:20480
    ds_read_b64_tr_b16 v[142:143], v35 offset:22528
    s_waitcnt lgkmcnt(12)
    ds_read_b64_tr_b16 v[144:145], v32 offset:24576
    ds_read_b64_tr_b16 v[146:147], v33 offset:26624
    s_waitcnt lgkmcnt(12)
    ds_read_b64_tr_b16 v[148:149], v34 offset:24576
    ds_read_b64_tr_b16 v[150:151], v35 offset:26624
    s_waitcnt lgkmcnt(12)
    ds_read_b64_tr_b16 v[152:153], v32 offset:28672
    ds_read_b64_tr_b16 v[154:155], v33 offset:30720
    s_waitcnt lgkmcnt(12)
    ds_read_b64_tr_b16 v[156:157], v34 offset:28672
    ds_read_b64_tr_b16 v[158:159], v35 offset:30720
    s_waitcnt lgkmcnt(0)
    s_setprio 2
    s_barrier
    ds_read_b128 v[64:67], v51 offset:0
    ds_read_b128 v[68:71], v51 offset:1024
    ds_read_b128 v[72:75], v51 offset:2048
    ds_read_b128 v[76:79], v51 offset:3072
    ds_read_b128 v[80:83], v51 offset:4096
    ds_read_b128 v[84:87], v51 offset:5120
    ds_read_b128 v[88:91], v51 offset:6144
    ds_read_b128 v[92:95], v51 offset:7168
    s_branch .LA_pv
.LA_comp:
    s_waitcnt lgkmcnt(0)
    s_mov_b32 s96, 4000000
.LA_n2p:
    s_sub_u32 s96, s96, 1
    s_cbranch_scc1 .LA_n2g
    s_sleep 20
    buffer_load_dword v11, v9, s[12:15], 0 offen offset:128 sc1
    s_waitcnt vmcnt(0)
    v_readfirstlane_b32 s40, v11
    s_cmp_eq_u32 s40, 0
    s_cbranch_scc1 .LA_n2p
.LA_n2g:
    v_lshrrev_b32 v7, 5, v0
    v_bfe_u32 v4, v0, 2, 2
    v_lshlrev_b32 v5, 10, v7
    v_lshl_add_u32 v5, v4, 8, v5
    v_lshl_add_u32 v5, v4, 6, v5
    v_bfe_u32 v6, v0, 4, 1
    v_bfe_u32 v4, v0, 1, 1
    v_lshl_add_u32 v6, v6, 1, v4
    v_xor_b32 v6, v6, v7
    v_lshl_add_u32 v5, v6, 4, v5
    v_lshl_add_u32 v5, v25, 3, v5
    s_lshr_b32 s45, s3, 2
    s_lshl_b32 s45, s45, 7
    v_xor_b32 v5, s45, v5
    s_lshl_b32 s44, s47, 15
    v_add_u32 v32, s44, v5
    v_mov_b32 v54, 0
    v_xor_b32 v33, 32, v32
    v_xor_b32 v34, 64, v32
    v_xor_b32 v35, 96, v32
    v_add_u32 v51, 133120, v8
    v_bfe_u32 v4, v0, 4, 1
    v_lshl_add_u32 v5, v7, 2, v4
    v_lshlrev_b32 v36, 17, v5
    v_lshl_add_u32 v36, v3, 3, v36
    v_mov_b32 v37, v36
    v_mov_b32 v38, v36
    v_mov_b32 v39, v36
    s_add_u32 s44, s44, s45
    s_lshl_b32 s45, s42, 8
    s_add_u32 s44, s44, s45
    s_add_u32 s44, s44, 4194304
    s_add_u32 s48, s44, 0
    s_add_u32 s49, s44, 262144
    s_add_u32 s50, s44, 1048576
    s_add_u32 s51, s44, 1310720
    s_add_u32 s52, s44, 2097152
    s_add_u32 s53, s44, 2359296
    s_add_u32 s54, s44, 3145728
    s_add_u32 s55, s44, 3407872
    v_and_b32 v5, 7, v0
    v_lshl_add_u32 v4, v5, 1, v4
    v_lshlrev_b32 v4, 1, v4
    v_lshrrev_b32 v4, v4, v11
    v_and_b32 v5, 1, v4
    v_bfe_u32 v4, v4, 1, 1
    v_lshl_or_b32 v53, v4, 16, v5
    s_mov_b32 s56, 0x00010001
    v_lshrrev_b32 v2, 5, v0
    v_and_b32 v3, 31, v0
    v_and_b32 v4, 3, v3
    v_bfe_u32 v5, v3, 2, 2
    v_lshl_or_b32 v5, v4, 2, v5
    v_xor_b32 v5, v5, v2
    v_lshlrev_b32 v5, 4, v5
    v_lshl_add_u32 v24, v3, 10, v5
    v_add_u32 v24, 131072, v24
    v_lshl_add_u32 v5, v4, 8, v5
    v_lshrrev_b32 v4, 2, v3
    v_lshl_add_u32 v5, v4, 10, v5
    s_lshl_b32 s45, s3, 13
    v_add_u32 v16, s45, v5
    v_xor_b32 v17, 32, v16
    v_xor_b32 v25, 32, v24
    v_xor_b32 v18, 64, v16
    v_xor_b32 v26, 64, v24
    v_xor_b32 v19, 96, v16
    v_xor_b32 v27, 96, v24
    v_xor_b32 v20, 128, v16
    v_xor_b32 v28, 128, v24
    v_xor_b32 v21, 160, v16
    v_xor_b32 v29, 160, v24
    v_xor_b32 v22, 192, v16
    v_xor_b32 v30, 192, v24
    v_xor_b32 v23, 224, v16
    v_xor_b32 v31, 224, v24
    s_lshl_b32 s45, s3, 7
    s_add_u32 s45, s45, 131072
    v_lshlrev_b32 v48, 2, v3
    v_add_u32 v49, 131072, v48
    v_add_u32 v48, s45, v48
    s_lshl_b32 s45, s3, 11
    s_add_u32 s45, s45, 133120
    v_add_u32 v50, s45, v8
    v_lshlrev_b32 v54, 4, v3
    s_lshl_b32 s46, s42, 11
    s_lshl_b32 s45, s3, 9
    s_add_u32 s46, s46, s45
    s_add_u32 s46, s46, 1048576
    s_mul_i32 s45, s40, 0x9E3779B1
    v_mov_b32 v58, s40
    v_mov_b32 v59, s45
    s_barrier
    ds_read_b128 v[208:211], v16 offset:0
    ds_read_b128 v[212:215], v24 offset:0
    ds_read_b128 v[216:219], v17 offset:0
    ds_read_b128 v[220:223], v25 offset:0
    ds_read_b128 v[224:227], v18 offset:0
    ds_read_b128 v[228:231], v26 offset:0
    ds_read_b128 v[232:235], v19 offset:0
    ds_read_b128 v[236:239], v27 offset:0
    s_waitcnt lgkmcnt(6)
    v_mfma_f32_32x32x16_bf16 v[64:79], v[208:211], v[212:215], 0
    ds_read_b128 v[208:211], v20 offset:0
    ds_read_b128 v[212:215], v28 offset:0
    s_waitcnt lgkmcnt(6)
    v_mfma_f32_32x32x16_bf16 v[64:79], v[216:219], v[220:223], v[64:79]
    ds_read_b128 v[216:219], v21 offset:0
    ds_read_b128 v[220:223], v29 offset:0
    s_waitcnt lgkmcnt(6)
    v_mfma_f32_32x32x16_bf16 v[64:79], v[224:227], v[228:231], v[64:79]
    ds_read_b128 v[224:227], v22 offset:0
    ds_read_b128 v[228:231], v30 offset:0
    s_waitcnt lgkmcnt(6)
    v_mfma_f32_32x32x16_bf16 v[64:79], v[232:235], v[236:239], v[64:79]
    ds_read_b128 v[232:235], v23 offset:0
    ds_read_b128 v[236:239], v31 offset:0
    s_waitcnt lgkmcnt(6)
    v_mfma_f32_32x32x16_bf16 v[64:79], v[208:211], v[212:215], v[64:79]
    ds_read_b128 v[208:211], v16 offset:32768
    ds_read_b128 v[212:215], v24 offset:256
    v_add_u32 v16, 0x10000, v16
    s_waitcnt lgkmcnt(6)
    v_mfma_f32_32x32x16_bf16 v[64:79], v[216:219], v[220:223], v[64:79]
    ds_read_b128 v[216:219], v17 offset:32768
    ds_read_b128 v[220:223], v25 offset:256
    v_add_u32 v17, 0x10000, v17
    s_waitcnt lgkmcnt(6)
    v_mfma_f32_32x32x16_bf16 v[64:79], v[224:227], v[228:231], v[64:79]
    ds_read_b128 v[224:227], v18 offset:32768
    ds_read_b128 v[228:231], v26 offset:256
    v_add_u32 v18, 0x10000, v18
    s_waitcnt lgkmcnt(6)
    v_mfma_f32_32x32x16_bf16 v[64:79], v[232:235], v[236:239], v[64:79]
    ds_read_b128 v[232:235], v19 offset:32768
    ds_read_b128 v[236:239], v27 offset:256
    v_add_u32 v19, 0x10000, v19
    s_waitcnt lgkmcnt(6)
    v_mfma_f32_32x32x16_bf16 v[64:79], v[208:211], v[212:215], v[64:79]
    ds_read_b128 v[208:211], v20 offset:32768
    ds_read_b128 v[212:215], v28 offset:256
    v_add_u32 v20, 0x10000, v20
    s_waitcnt lgkmcnt(6)
    v_mfma_f32_32x32x16_bf16 v[64:79], v[216:219], v[220:223], v[64:79]
    ds_read_b128 v[216:219], v21 offset:32768
    ds_read_b128 v[220:223], v29 offset:256
    v_add_u32 v21, 0x10000, v21
    s_waitcnt lgkmcnt(6)
    v_mfma_f32_32x32x16_bf16 v[64:79], v[224:227], v[228:231], v[64:79]
    ds_read_b128 v[224:227], v22 offset:32768
    ds_read_b128 v[228:231], v30 offset:256
    v_add_u32 v22, 0x10000, v22
    s_waitcnt lgkmcnt(6)
    v_mfma_f32_32x32x16_bf16 v[64:79], v[232:235], v[236:239], v[64:79]
    ds_read_b128 v[232:235], v23 offset:32768
    ds_read_b128 v[236:239], v31 offset:256
    v_add_u32 v23, 0x10000, v23
    s_waitcnt lgkmcnt(6)
    v_mfma_f32_32x32x16_bf16 v[64:79], v[208:211], v[212:215], v[64:79]
    ds_read_b128 v[208:211], v16 offset:0
    ds_read_b128 v[212:215], v24 offset:512
    s_waitcnt lgkmcnt(6)
    v_mfma_f32_32x32x16_bf16 v[64:79], v[216:219], v[220:223], v[64:79]
    ds_read_b128 v[216:219], v17 offset:0
    ds_read_b128 v[220:223], v25 offset:512
    s_waitcnt lgkmcnt(6)
    v_mfma_f32_32x32x16_bf16 v[64:79], v[224:227], v[228:231], v[64:79]
    ds_read_b128 v[224:227], v18 offset:0
    ds_read_b128 v[228:231], v26 offset:512
    s_waitcnt lgkmcnt(6)
    v_mfma_f32_32x32x16_bf16 v[64:79], v[232:235], v[236:239], v[64:79]
    ds_read_b128 v[232:235], v19 offset:0
    ds_read_b128 v[236:239], v27 offset:512
    s_waitcnt lgkmcnt(6)
    v_mfma_f32_32x32x16_bf16 v[64:79], v[208:211], v[212:215], v[64:79]
    ds_read_b128 v[208:211], v20 offset:0
    ds_read_b128 v[212:215], v28 offset:512
    s_waitcnt lgkmcnt(6)
    v_mfma_f32_32x32x16_bf16 v[64:79], v[216:219], v[220:223], v[64:79]
    ds_read_b128 v[216:219], v21 offset:0
    ds_read_b128 v[220:223], v29 offset:512
    s_waitcnt lgkmcnt(6)
    v_mfma_f32_32x32x16_bf16 v[64:79], v[224:227], v[228:231], v[64:79]
    ds_read_b128 v[224:227], v22 offset:0
    ds_read_b128 v[228:231], v30 offset:512
    s_waitcnt lgkmcnt(6)
    v_mfma_f32_32x32x16_bf16 v[64:79], v[232:235], v[236:239], v[64:79]
    ds_read_b128 v[232:235], v23 offset:0
    ds_read_b128 v[236:239], v31 offset:512
    s_waitcnt lgkmcnt(6)
    v_mfma_f32_32x32x16_bf16 v[64:79], v[208:211], v[212:215], v[64:79]
    ds_read_b128 v[208:211], v16 offset:32768
    ds_read_b128 v[212:215], v24 offset:768
    s_waitcnt lgkmcnt(6)
    v_mfma_f32_32x32x16_bf16 v[64:79], v[216:219], v[220:223], v[64:79]
    ds_read_b128 v[216:219], v17 offset:32768
    ds_read_b128 v[220:223], v25 offset:768
    s_waitcnt lgkmcnt(6)
    v_mfma_f32_32x32x16_bf16 v[64:79], v[224:227], v[228:231], v[64:79]
    ds_read_b128 v[224:227], v18 offset:32768
    ds_read_b128 v[228:231], v26 offset:768
    s_waitcnt lgkmcnt(6)
    v_mfma_f32_32x32x16_bf16 v[64:79], v[232:235], v[236:239], v[64:79]
    ds_read_b128 v[232:235], v19 offset:32768
    ds_read_b128 v[236:239], v27 offset:768
    s_waitcnt lgkmcnt(6)
    v_mfma_f32_32x32x16_bf16 v[64:79], v[208:211], v[212:215], v[64:79]
    ds_read_b128 v[208:211], v20 offset:32768
    ds_read_b128 v[212:215], v28 offset:768
    s_waitcnt lgkmcnt(6)
    v_mfma_f32_32x32x16_bf16 v[64:79], v[216:219], v[220:223], v[64:79]
    ds_read_b128 v[216:219], v21 offset:32768
    ds_read_b128 v[220:223], v29 offset:768
    s_waitcnt lgkmcnt(6)
    v_mfma_f32_32x32x16_bf16 v[64:79], v[224:227], v[228:231], v[64:79]
    ds_read_b128 v[224:227], v22 offset:32768
    ds_read_b128 v[228:231], v30 offset:768
    s_waitcnt lgkmcnt(6)
    v_mfma_f32_32x32x16_bf16 v[64:79], v[232:235], v[236:239], v[64:79]
    ds_read_b128 v[232:235], v23 offset:32768
    ds_read_b128 v[236:239], v31 offset:768
    s_waitcnt lgkmcnt(6)
    v_mfma_f32_32x32x16_bf16 v[64:79], v[208:211], v[212:215], v[64:79]
    s_waitcnt lgkmcnt(4)
    v_mfma_f32_32x32x16_bf16 v[64:79], v[216:219], v[220:223], v[64:79]
    s_waitcnt lgkmcnt(2)
    v_mfma_f32_32x32x16_bf16 v[64:79], v[224:227], v[228:231], v[64:79]
    s_waitcnt lgkmcnt(0)
    s_barrier
    v_mfma_f32_32x32x16_bf16 v[64:79], v[232:235], v[236:239], v[64:79]
    s_nop 11
    v_max3_f32 v4, v64, v65, v66
    v_max3_f32 v5, v67, v68, v69
    v_max3_f32 v6, v70, v71, v72
    v_max3_f32 v7, v73, v74, v75
    v_max3_f32 v4, v4, v76, v77
    v_max3_f32 v5, v5, v78, v79
    v_max3_f32 v4, v4, v6, v7
    v_max_f32 v4, v4, v5
    v_mov_b32 v5, v4
    s_nop 1
    v_permlane32_swap_b32 v4, v5
    v_max_f32 v4, v4, v5
    ds_write_b32 v48, v4
    s_waitcnt lgkmcnt(0)
    s_barrier
    ds_read2_b32 v[4:5], v49 offset0:0 offset1:32
    ds_read2_b32 v[6:7], v49 offset0:64 offset1:96
    s_waitcnt lgkmcnt(0)
    v_max3_f32 v4, v4, v5, v6
    v_max_f32 v56, v4, v7
    v_pk_add_f32 v[64:65], v[64:65], v[56:57] op_sel_hi:[1,0] neg_lo:[0,1] neg_hi:[0,1]
    v_pk_add_f32 v[66:67], v[66:67], v[56:57] op_sel_hi:[1,0] neg_lo:[0,1] neg_hi:[0,1]
    v_pk_add_f32 v[68:69], v[68:69], v[56:57] op_sel_hi:[1,0] neg_lo:[0,1] neg_hi:[0,1]
    v_pk_add_f32 v[70:71], v[70:71], v[56:57] op_sel_hi:[1,0] neg_lo:[0,1] neg_hi:[0,1]
    v_exp_f32 v64, v64
    v_pk_add_f32 v[72:73], v[72:73], v[56:57] op_sel_hi:[1,0] neg_lo:[0,1] neg_hi:[0,1]
    v_exp_f32 v65, v65
    v_pk_add_f32 v[74:75], v[74:75], v[56:57] op_sel_hi:[1,0] neg_lo:[0,1] neg_hi:[0,1]
    v_exp_f32 v66, v66
    v_pk_add_f32 v[76:77], v[76:77], v[56:57] op_sel_hi:[1,0] neg_lo:[0,1] neg_hi:[0,1]
    v_exp_f32 v67, v67
    v_pk_add_f32 v[78:79], v[78:79], v[56:57] op_sel_hi:[1,0] neg_lo:[0,1] neg_hi:[0,1]
    v_exp_f32 v68, v68
    v_exp_f32 v69, v69
    v_exp_f32 v70, v70
    v_exp_f32 v71, v71
    v_exp_f32 v72, v72
    v_exp_f32 v73, v73
    v_cvt_pk_bf16_f32 v80, v64, v65
    v_exp_f32 v74, v74
    v_exp_f32 v75, v75
    v_cvt_pk_bf16_f32 v81, v66, v67
    v_exp_f32 v76, v76
    v_exp_f32 v77, v77
    v_cvt_pk_bf16_f32 v82, v68, v69
    v_exp_f32 v78, v78
    v_exp_f32 v79, v79
    v_cvt_pk_bf16_f32 v83, v70, v71
    ds_write_b128 v50, v[80:83]
    v_cvt_pk_bf16_f32 v84, v72, v73
    v_cvt_pk_bf16_f32 v85, v74, v75
    v_cvt_pk_bf16_f32 v86, v76, v77
    v_cvt_pk_bf16_f32 v87, v78, v79
    ds_write_b128 v50, v[84:87] offset:1024
    v_pk_add_f32 v[64:65], v[64:65], v[72:73]
    v_pk_add_f32 v[66:67], v[66:67], v[74:75]
    v_pk_add_f32 v[68:69], v[68:69], v[76:77]
    v_pk_add_f32 v[70:71], v[70:71], v[78:79]
    v_pk_add_f32 v[64:65], v[64:65], v[68:69]
    v_pk_add_f32 v[66:67], v[66:67], v[70:71]
    v_pk_add_f32 v[64:65], v[64:65], v[66:67]
    v_add_f32 v64, v64, v65
    v_mov_b32 v65, v64
    s_nop 1
    v_permlane32_swap_b32 v64, v65
    v_add_f32 v64, v64, v65
    ds_write_b32 v48, v64 offset:512
    s_waitcnt lgkmcnt(0)
    s_barrier
    s_waitcnt lgkmcnt(0)
    ds_read2_b32 v[4:5], v49 offset0:128 offset1:160
    ds_read2_b32 v[6:7], v49 offset0:192 offset1:224
    ds_read_b128 v[64:67], v51 offset:0
    ds_read_b128 v[68:71], v51 offset:1024
    ds_read_b128 v[72:75], v51 offset:2048
    ds_read_b128 v[76:79], v51 offset:3072
    ds_read_b128 v[80:83], v51 offset:4096
    ds_read_b128 v[84:87], v51 offset:5120
    ds_read_b128 v[88:91], v51 offset:6144
    ds_read_b128 v[92:95], v51 offset:7168
    s_waitcnt lgkmcnt(8)
    v_add_f32 v4, v4, v5
    v_add_f32 v6, v6, v7
    v_add_f32 v57, v4, v6
    s_mov_b32 exec_hi, 0
    buffer_store_dwordx4 v[56:59], v54, s[8:11], s46 offen sc1
    s_mov_b64 exec, -1
    s_waitcnt lgkmcnt(12)
    ds_read_b64_tr_b16 v[96:97], v32 offset:0
    ds_read_b64_tr_b16 v[98:99], v33 offset:2048
    s_waitcnt lgkmcnt(12)
    ds_read_b64_tr_b16 v[100:101], v34 offset:0
    ds_read_b64_tr_b16 v[102:103], v35 offset:2048
    s_waitcnt lgkmcnt(12)
    ds_read_b64_tr_b16 v[104:105], v32 offset:4096
    ds_read_b64_tr_b16 v[106:107], v33 offset:6144
    s_waitcnt lgkmcnt(12)
    ds_read_b64_tr_b16 v[108:109], v34 offset:4096
    ds_read_b64_tr_b16 v[110:111], v35 offset:6144
    s_waitcnt lgkmcnt(12)
    ds_read_b64_tr_b16 v[112:113], v32 offset:8192
    ds_read_b64_tr_b16 v[114:115], v33 offset:10240
    s_waitcnt lgkmcnt(12)
    ds_read_b64_tr_b16 v[116:117], v34 offset:8192
    ds_read_b64_tr_b16 v[118:119], v35 offset:10240
    s_waitcnt lgkmcnt(12)
    ds_read_b64_tr_b16 v[120:121], v32 offset:12288
    ds_read_b64_tr_b16 v[122:123], v33 offset:14336
    s_waitcnt lgkmcnt(12)
    ds_read_b64_tr_b16 v[124:125], v34 offset:12288
    ds_read_b64_tr_b16 v[126:127], v35 offset:14336
    s_waitcnt lgkmcnt(12)
    ds_read_b64_tr_b16 v[128:129], v32 offset:16384
    ds_read_b64_tr_b16 v[130:131], v33 offset:18432
    s_waitcnt lgkmcnt(12)
    ds_read_b64_tr_b16 v[132:133], v34 offset:16384
    ds_read_b64_tr_b16 v[134:135], v35 offset:18432
    s_waitcnt lgkmcnt(12)
    ds_read_b64_tr_b16 v[136:137], v32 offset:20480
    ds_read_b64_tr_b16 v[138:139], v33 offset:22528
    s_waitcnt lgkmcnt(12)
    ds_read_b64_tr_b16 v[140:141], v34 offset:20480
    ds_read_b64_tr_b16 v[142:143], v35 offset:22528
    s_waitcnt lgkmcnt(12)
    ds_read_b64_tr_b16 v[144:145], v32 offset:24576
    ds_read_b64_tr_b16 v[146:147], v33 offset:26624
    s_waitcnt lgkmcnt(12)
    ds_read_b64_tr_b16 v[148:149], v34 offset:24576
    ds_read_b64_tr_b16 v[150:151], v35 offset:26624
    s_waitcnt lgkmcnt(12)
    ds_read_b64_tr_b16 v[152:153], v32 offset:28672
    ds_read_b64_tr_b16 v[154:155], v33 offset:30720
    s_waitcnt lgkmcnt(12)
    ds_read_b64_tr_b16 v[156:157], v34 offset:28672
    ds_read_b64_tr_b16 v[158:159], v35 offset:30720
    s_waitcnt lgkmcnt(0)
.LA_pv:
    s_waitcnt lgkmcnt(7)
    v_mfma_f32_32x32x16_bf16 v[160:175], v[64:67], v[96:99], 0
    v_mfma_f32_32x32x16_bf16 v[176:191], v[64:67], v[100:103], 0
    s_waitcnt lgkmcnt(6)
    v_mfma_f32_32x32x16_bf16 v[160:175], v[68:71], v[104:107], v[160:175]
    v_mfma_f32_32x32x16_bf16 v[176:191], v[68:71], v[108:111], v[176:191]
    s_waitcnt lgkmcnt(5)
    v_mfma_f32_32x32x16_bf16 v[160:175], v[72:75], v[112:115], v[160:175]
    v_mfma_f32_32x32x16_bf16 v[176:191], v[72:75], v[116:119], v[176:191]
    s_waitcnt lgkmcnt(4)
    v_mfma_f32_32x32x16_bf16 v[160:175], v[76:79], v[120:123], v[160:175]
    v_mfma_f32_32x32x16_bf16 v[176:191], v[76:79], v[124:127], v[176:191]
    s_waitcnt lgkmcnt(3)
    v_mfma_f32_32x32x16_bf16 v[160:175], v[80:83], v[128:131], v[160:175]
    v_mfma_f32_32x32x16_bf16 v[176:191], v[80:83], v[132:135], v[176:191]
    s_waitcnt lgkmcnt(2)
    v_mfma_f32_32x32x16_bf16 v[160:175], v[84:87], v[136:139], v[160:175]
    v_mfma_f32_32x32x16_bf16 v[176:191], v[84:87], v[140:143], v[176:191]
    s_waitcnt lgkmcnt(1)
    v_mfma_f32_32x32x16_bf16 v[160:175], v[88:91], v[144:147], v[160:175]
    v_mfma_f32_32x32x16_bf16 v[176:191], v[88:91], v[148:151], v[176:191]
    s_waitcnt lgkmcnt(0)
    v_mfma_f32_32x32x16_bf16 v[160:175], v[92:95], v[152:155], v[160:175]
    v_mfma_f32_32x32x16_bf16 v[176:191], v[92:95], v[156:159], v[176:191]
    s_setprio 0
    s_nop 10
    v_cvt_pk_bf16_f32 v192, v160, v176
    v_cvt_pk_bf16_f32 v193, v161, v177
    v_bfi_b32 v192, s56, v53, v192
    v_bfi_b32 v193, s56, v53, v193
    v_cvt_pk_bf16_f32 v194, v162, v178
    v_cvt_pk_bf16_f32 v195, v163, v179
    v_bfi_b32 v194, s56, v53, v194
    v_bfi_b32 v195, s56, v53, v195
    v_permlane16_swap_b32 v192, v193
    buffer_store_dwordx2 v[192:193], v36, s[8:11], s48 offen sc1
    v_cvt_pk_bf16_f32 v196, v164, v180
    v_cvt_pk_bf16_f32 v197, v165, v181
    v_bfi_b32 v196, s56, v53, v196
    v_bfi_b32 v197, s56, v53, v197
    v_permlane16_swap_b32 v194, v195
    buffer_store_dwordx2 v[194:195], v37, s[8:11], s49 offen sc1
    v_cvt_pk_bf16_f32 v198, v166, v182
    v_cvt_pk_bf16_f32 v199, v167, v183
    v_bfi_b32 v198, s56, v53, v198
    v_bfi_b32 v199, s56, v53, v199
    v_permlane16_swap_b32 v196, v197
    buffer_store_dwordx2 v[196:197], v38, s[8:11], s50 offen sc1
    v_cvt_pk_bf16_f32 v200, v168, v184
    v_cvt_pk_bf16_f32 v201, v169, v185
    v_bfi_b32 v200, s56, v53, v200
    v_bfi_b32 v201, s56, v53, v201
    v_permlane16_swap_b32 v198, v199
    buffer_store_dwordx2 v[198:199], v39, s[8:11], s51 offen sc1
    v_cvt_pk_bf16_f32 v202, v170, v186
    v_cvt_pk_bf16_f32 v203, v171, v187
    v_bfi_b32 v202, s56, v53, v202
    v_bfi_b32 v203, s56, v53, v203
    v_permlane16_swap_b32 v200, v201
    buffer_store_dwordx2 v[200:201], v36, s[8:11], s52 offen sc1
    v_cvt_pk_bf16_f32 v204, v172, v188
    v_cvt_pk_bf16_f32 v205, v173, v189
    v_bfi_b32 v204, s56, v53, v204
    v_bfi_b32 v205, s56, v53, v205
    v_permlane16_swap_b32 v202, v203
    buffer_store_dwordx2 v[202:203], v37, s[8:11], s53 offen sc1
    v_cvt_pk_bf16_f32 v206, v174, v190
    v_cvt_pk_bf16_f32 v207, v175, v191
    v_bfi_b32 v206, s56, v53, v206
    v_bfi_b32 v207, s56, v53, v207
    v_permlane16_swap_b32 v204, v205
    buffer_store_dwordx2 v[204:205], v38, s[8:11], s54 offen sc1
    s_nop 1
    v_permlane16_swap_b32 v206, v207
    buffer_store_dwordx2 v[206:207], v39, s[8:11], s55 offen sc1
    s_cmp_lt_u32 s3, 4
    s_cbranch_scc1 .LA_zq
    s_cmp_ge_u32 s43, 85
    s_cbranch_scc1 .LH_F2
    s_cmp_ge_u32 s43, 32
    s_cbranch_scc1 .LA_exit
    s_cmp_lg_u32 s3, 4
    s_cbranch_scc1 .LA_exit
    v_and_b32 v3, 7, v0
    v_lshrrev_b32 v2, 3, v0
    v_lshlrev_b32 v4, 12, v2
    v_lshl_add_u32 v4, v3, 4, v4
    v_mov_b32 v10, s40
    s_mov_b32 s100, 0x9E3779B1
    v_mul_lo_u32 v12, v10, s100
    v_lshrrev_b32 v11, 12, v10
    v_lshrrev_b32 v13, 20, v12
    v_lshrrev_b32 v12, 8, v12
    s_movk_i32 s100, 0xfff
    s_lshl_b32 s46, s43, 7
    s_add_u32 s46, s46, 3145728
    v_mov_b32 v52, 0
    v_mov_b32 v53, 0
    v_mov_b32 v54, 0
    v_mov_b32 v55, 0
    s_mov_b64 s[50:51], -1
    s_mov_b64 s[52:53], -1
    s_mov_b64 s[54:55], -1
    s_mov_b64 s[56:57], -1
    s_mov_b64 s[58:59], -1
    s_mov_b64 s[60:61], 0xffffff
    s_mov_b32 s96, 4000000
.LZ_f_1:
    s_sub_u32 s96, s96, 1
    s_cbranch_scc1 .LZ_f_2
    s_sleep 1
    s_mov_b64 exec, s[50:51]
    buffer_load_dwordx4 v[32:35], v4, s[8:11], s46 offen sc1
    s_waitcnt vmcnt(0)
    v_xor_b32 v20, v32, v10
    v_bitop3_b32 v20, v20, v33, v11 bitop3:0xf6
    v_bitop3_b32 v20, v20, v34, v12 bitop3:0xf6
    v_bitop3_b32 v20, v20, v35, v13 bitop3:0xf6
    v_and_b32 v20, 0xfff, v20
    v_cmp_ne_u32 s[50:51], 0, v20
    s_bcnt1_i32_b64 s48, s[50:51]
    s_cmp_gt_u32 s48, 32
    s_cbranch_scc1 .LZ_f_1
.LZ_f_2:
    s_mov_b32 s96, 4000000
.LZ_f_p:
    s_sub_u32 s96, s96, 1
    s_cbranch_scc1 .LZ_f_ok
    s_mov_b64 exec, s[50:51]
    s_cbranch_execz .LZ_f_s0
    buffer_load_dwordx4 v[32:35], v4, s[8:11], s46 offen sc1
.LZ_f_s0:
    s_mov_b64 exec, s[52:53]
    s_cbranch_execz .LZ_f_s1
    s_add_u32 s48, s46, 32768
    buffer_load_dwordx4 v[36:39], v4, s[8:11], s48 offen sc1
.LZ_f_s1:
    s_mov_b64 exec, s[54:55]
    s_cbranch_execz .LZ_f_s2
    s_add_u32 s48, s46, 65536
    buffer_load_dwordx4 v[40:43], v4, s[8:11], s48 offen sc1
.LZ_f_s2:
    s_mov_b64 exec, s[56:57]
    s_cbranch_execz .LZ_f_s3
    s_add_u32 s48, s46, 98304
    buffer_load_dwordx4 v[44:47], v4, s[8:11], s48 offen sc1
.LZ_f_s3:
    s_mov_b64 exec, s[58:59]
    s_cbranch_execz .LZ_f_s4
    s_add_u32 s48, s46, 131072
    buffer_load_dwordx4 v[48:51], v4, s[8:11], s48 offen sc1
.LZ_f_s4:
    s_mov_b64 exec, s[60:61]
    s_cbranch_execz .LZ_f_s5
    s_add_u32 s48, s46, 163840
    buffer_load_dwordx4 v[52:55], v4, s[8:11], s48 offen sc1
.LZ_f_s5:
    s_waitcnt vmcnt(0)
    s_mov_b64 vcc, 0
    s_mov_b64 exec, -1
    v_xor_b32 v60, v32, v10
    v_bitop3_b32 v60, v60, v33, v11 bitop3:0xf6
    v_bitop3_b32 v60, v60, v34, v12 bitop3:0xf6
    v_bitop3_b32 v60, v60, v35, v13 bitop3:0xf6
    v_xor_b32 v61, v36, v10
    v_bitop3_b32 v61, v61, v37, v11 bitop3:0xf6
    v_bitop3_b32 v61, v61, v38, v12 bitop3:0xf6
    v_bitop3_b32 v61, v61, v39, v13 bitop3:0xf6
    v_xor_b32 v62, v40, v10
    v_bitop3_b32 v62, v62, v41, v11 bitop3:0xf6
    v_bitop3_b32 v62, v62, v42, v12 bitop3:0xf6
    v_bitop3_b32 v62, v62, v43, v13 bitop3:0xf6
    v_xor_b32 v63, v44, v10
    v_bitop3_b32 v63, v63, v45, v11 bitop3:0xf6
    v_bitop3_b32 v63, v63, v46, v12 bitop3:0xf6
    v_bitop3_b32 v63, v63, v47, v13 bitop3:0xf6
    v_xor_b32 v64, v48, v10
    v_bitop3_b32 v64, v64, v49, v11 bitop3:0xf6
    v_bitop3_b32 v64, v64, v50, v12 bitop3:0xf6
    v_bitop3_b32 v64, v64, v51, v13 bitop3:0xf6
    v_xor_b32 v65, v52, v10
    v_bitop3_b32 v65, v65, v53, v11 bitop3:0xf6
    v_bitop3_b32 v65, v65, v54, v12 bitop3:0xf6
    v_bitop3_b32 v65, v65, v55, v13 bitop3:0xf6
    v_and_b32 v60, 0xfff, v60
    v_and_b32 v61, 0xfff, v61
    v_and_b32 v62, 0xfff, v62
    v_and_b32 v63, 0xfff, v63
    v_and_b32 v64, 0xfff, v64
    v_and_b32 v65, 0xfff, v65
    s_mov_b64 exec, s[50:51]
    v_cmp_ne_u32 s[50:51], 0, v60
    s_or_b64 vcc, vcc, s[50:51]
    s_mov_b64 exec, s[52:53]
    v_cmp_ne_u32 s[52:53], 0, v61
    s_or_b64 vcc, vcc, s[52:53]
    s_mov_b64 exec, s[54:55]
    v_cmp_ne_u32 s[54:55], 0, v62
    s_or_b64 vcc, vcc, s[54:55]
    s_mov_b64 exec, s[56:57]
    v_cmp_ne_u32 s[56:57], 0, v63
    s_or_b64 vcc, vcc, s[56:57]
    s_mov_b64 exec, s[58:59]
    v_cmp_ne_u32 s[58:59], 0, v64
    s_or_b64 vcc, vcc, s[58:59]
    s_mov_b64 exec, s[60:61]
    v_cmp_ne_u32 s[60:61], 0, v65
    s_or_b64 vcc, vcc, s[60:61]
    s_cbranch_vccnz .LZ_f_p
.LZ_f_ok:
    s_mov_b64 exec, -1
    v_add_f32 v32, v32, v36
    v_add_f32 v33, v33, v37
    v_add_f32 v34, v34, v38
    v_add_f32 v35, v35, v39
    v_add_f32 v32, v32, v40
    v_add_f32 v33, v33, v41
    v_add_f32 v34, v34, v42
    v_add_f32 v35, v35, v43
    v_add_f32 v32, v32, v44
    v_add_f32 v33, v33, v45
    v_add_f32 v34, v34, v46
    v_add_f32 v35, v35, v47
    v_add_f32 v32, v32, v48
    v_add_f32 v33, v33, v49
    v_add_f32 v34, v34, v50
    v_add_f32 v35, v35, v51
    v_add_f32 v32, v32, v52
    v_add_f32 v33, v33, v53
    v_add_f32 v34, v34, v54
    v_add_f32 v35, v35, v55
    s_nop 0
    v_add_f32_dpp v32, v32, v32 row_ror:8 row_mask:0xf bank_mask:0xf
    v_add_f32_dpp v33, v33, v33 row_ror:8 row_mask:0xf bank_mask:0xf
    v_add_f32_dpp v34, v34, v34 row_ror:8 row_mask:0xf bank_mask:0xf
    v_add_f32_dpp v35, v35, v35 row_ror:8 row_mask:0xf bank_mask:0xf
    v_mov_b32 v36, v32
    v_mov_b32 v37, v33
    v_mov_b32 v38, v34
    v_mov_b32 v39, v35
    s_nop 0
    v_permlane16_swap_b32 v32, v36
    v_permlane16_swap_b32 v33, v37
    v_permlane16_swap_b32 v34, v38
    v_permlane16_swap_b32 v35, v39
    v_add_f32 v32, v32, v36
    v_add_f32 v33, v33, v37
    v_add_f32 v34, v34, v38
    v_add_f32 v35, v35, v39
    v_mov_b32 v36, v32
    v_mov_b32 v37, v33
    v_mov_b32 v38, v34
    v_mov_b32 v39, v35
    s_nop 0
    v_permlane32_swap_b32 v32, v36
    v_permlane32_swap_b32 v33, v37
    v_permlane32_swap_b32 v34, v38
    v_permlane32_swap_b32 v35, v39
    v_add_f32 v32, v32, v36
    v_add_f32 v33, v33, v37
    v_add_f32 v34, v34, v38
    v_add_f32 v35, v35, v39
    v_cvt_pk_bf16_f32 v32, v32, v33
    v_cvt_pk_bf16_f32 v34, v34, v35
    v_lshlrev_b32 v24, 16, v32
    v_and_b32 v25, 0xffff0000, v32
    v_lshlrev_b32 v26, 16, v34
    v_and_b32 v27, 0xffff0000, v34
    v_mul_f32 v32, 0xbfb8aa3b, v24
    v_mul_f32 v33, 0xbfb8aa3b, v25
    v_mul_f32 v34, 0xbfb8aa3b, v26
    v_mul_f32 v35, 0xbfb8aa3b, v27
    v_exp_f32 v32, v32
    v_exp_f32 v33, v33
    v_exp_f32 v34, v34
    v_exp_f32 v35, v35
    s_nop 0
    v_add_f32 v32, 1.0, v32
    v_add_f32 v33, 1.0, v33
    v_add_f32 v34, 1.0, v34
    v_add_f32 v35, 1.0, v35
    v_rcp_f32 v32, v32
    v_rcp_f32 v33, v33
    v_rcp_f32 v34, v34
    v_rcp_f32 v35, v35
    s_nop 0
    v_mul_f32 v24, v24, v32
    v_mul_f32 v25, v25, v33
    v_mul_f32 v26, v26, v34
    v_mul_f32 v27, v27, v35
    v_cvt_pk_bf16_f32 v32, v24, v25
    v_cvt_pk_bf16_f32 v34, v26, v27
    v_lshlrev_b32 v24, 16, v32
    v_and_b32 v25, 0xffff0000, v32
    v_lshlrev_b32 v26, 16, v34
    v_and_b32 v27, 0xffff0000, v34
    v_lshlrev_b32 v15, 4, v3
    v_add_u32 v15, 143360, v15
    s_mov_b64 exec, 0xff
    ds_write_b128 v15, v[24:27]
    s_waitcnt lgkmcnt(0)
    s_branch .LA_exit
.LH_F2:
    v_lshrrev_b32 v7, 3, v0
    v_lshlrev_b32 v7, 9, v7
    v_and_b32 v10, 7, v0
    v_lshl_add_u32 v7, v10, 4, v7
    s_lshr_b32 s44, s62, 2
    s_lshl_b32 s44, s44, 15
    s_and_b32 s45, s62, 3
    s_lshl_b32 s45, s45, 7
    s_add_u32 s44, s44, s45
    s_add_u32 s44, s44, 3670016
    s_mov_b32 s45, s44
    buffer_load_dwordx4 v[32:35], v7, s[8:11], s45 offen sc1
    s_add_u32 s45, s45, 4096
    buffer_load_dwordx4 v[36:39], v7, s[8:11], s45 offen sc1
    s_add_u32 s45, s45, 4096
    buffer_load_dwordx4 v[40:43], v7, s[8:11], s45 offen sc1
    s_add_u32 s45, s45, 4096
    buffer_load_dwordx4 v[44:47], v7, s[8:11], s45 offen sc1
    s_add_u32 s45, s45, 4096
    buffer_load_dwordx4 v[48:51], v7, s[8:11], s45 offen sc1
    s_add_u32 s45, s45, 4096
    buffer_load_dwordx4 v[52:55], v7, s[8:11], s45 offen sc1
    s_add_u32 s45, s45, 4096
    buffer_load_dwordx4 v[56:59], v7, s[8:11], s45 offen sc1
    s_add_u32 s45, s45, 4096
    buffer_load_dwordx4 v[60:63], v7, s[8:11], s45 offen sc1
    s_mov_b32 s52, 0x05040100
    s_mov_b32 s53, 0x07060302
    s_mov_b32 s54, 0xffff0000
    s_mov_b32 s55, 0xffff0000
    s_mov_b32 s56, 0
    s_mov_b32 s57, -1
    v_and_b32 v26, 1, v2
    v_lshlrev_b32 v27, 5, v3
    v_lshl_add_u32 v27, v26, 4, v27
    s_mov_b32 s100, 0x9E3779B1
    v_mul_lo_u32 v30, v11, s100
    v_lshrrev_b32 v29, 12, v11
    v_mov_b32 v28, v11
    v_lshrrev_b32 v31, 20, v30
    v_lshrrev_b32 v30, 8, v30
    s_movk_i32 s100, 0xfff
    s_mov_b32 s100, 0x9E3779B1
    v_mul_lo_u32 v14, v11, s100
    v_lshrrev_b32 v13, 12, v11
    v_mov_b32 v12, v11
    v_lshrrev_b32 v15, 20, v14
    v_lshrrev_b32 v14, 8, v14
    s_movk_i32 s100, 0xfff
    v_lshlrev_b32 v16, 5, v25
    v_lshl_add_u32 v16, v2, 3, v16
    v_add_u32 v17, 4, v16
    v_lshrrev_b32 v26, 1, v2
    v_lshl_add_u32 v6, v26, 11, v27
    s_lshl_b32 s61, s62, 12
    s_lshl_b32 s45, s47, 9
    s_add_u32 s61, s61, s45
    s_add_u32 s61, s61, 3145728
    s_waitcnt vmcnt(16)
    v_perm_b32 v128, v212, v208, s52
    v_perm_b32 v129, v220, v216, s52
    v_perm_b32 v130, v228, v224, s52
    v_perm_b32 v131, v236, v232, s52
    v_perm_b32 v132, v212, v208, s53
    v_perm_b32 v133, v220, v216, s53
    v_perm_b32 v134, v228, v224, s53
    v_perm_b32 v135, v236, v232, s53
    v_perm_b32 v136, v213, v209, s52
    v_perm_b32 v137, v221, v217, s52
    v_perm_b32 v138, v229, v225, s52
    v_perm_b32 v139, v237, v233, s52
    v_perm_b32 v140, v213, v209, s53
    v_perm_b32 v141, v221, v217, s53
    v_perm_b32 v142, v229, v225, s53
    v_perm_b32 v143, v237, v233, s53
    v_perm_b32 v144, v214, v210, s52
    v_perm_b32 v145, v222, v218, s52
    v_perm_b32 v146, v230, v226, s52
    v_perm_b32 v147, v238, v234, s52
    v_perm_b32 v148, v214, v210, s53
    v_perm_b32 v149, v222, v218, s53
    v_perm_b32 v150, v230, v226, s53
    v_perm_b32 v151, v238, v234, s53
    v_perm_b32 v152, v215, v211, s52
    v_perm_b32 v153, v223, v219, s52
    v_perm_b32 v154, v231, v227, s52
    v_perm_b32 v155, v239, v235, s52
    v_perm_b32 v156, v215, v211, s53
    v_perm_b32 v157, v223, v219, s53
    v_perm_b32 v158, v231, v227, s53
    v_perm_b32 v159, v239, v235, s53
    s_mov_b32 s96, 4000000
.LF_gp:
    s_waitcnt vmcnt(0)
    v_xor_b32 v18, v32, v12
    v_bitop3_b32 v18, v18, v33, v13 bitop3:0xf6
    v_bitop3_b32 v18, v18, v34, v14 bitop3:0xf6
    v_bitop3_b32 v18, v18, v35, v15 bitop3:0xf6
    v_bitop3_b32 v18, v18, v36, v12 bitop3:0xf6
    v_bitop3_b32 v18, v18, v37, v13 bitop3:0xf6
    v_bitop3_b32 v18, v18, v38, v14 bitop3:0xf6
    v_bitop3_b32 v18, v18, v39, v15 bitop3:0xf6
    v_bitop3_b32 v18, v18, v40, v12 bitop3:0xf6
    v_bitop3_b32 v18, v18, v41, v13 bitop3:0xf6
    v_bitop3_b32 v18, v18, v42, v14 bitop3:0xf6
    v_bitop3_b32 v18, v18, v43, v15 bitop3:0xf6
    v_bitop3_b32 v18, v18, v44, v12 bitop3:0xf6
    v_bitop3_b32 v18, v18, v45, v13 bitop3:0xf6
    v_bitop3_b32 v18, v18, v46, v14 bitop3:0xf6
    v_bitop3_b32 v18, v18, v47, v15 bitop3:0xf6
    v_bitop3_b32 v18, v18, v48, v12 bitop3:0xf6
    v_bitop3_b32 v18, v18, v49, v13 bitop3:0xf6
    v_bitop3_b32 v18, v18, v50, v14 bitop3:0xf6
    v_bitop3_b32 v18, v18, v51, v15 bitop3:0xf6
    v_bitop3_b32 v18, v18, v52, v12 bitop3:0xf6
    v_bitop3_b32 v18, v18, v53, v13 bitop3:0xf6
    v_bitop3_b32 v18, v18, v54, v14 bitop3:0xf6
    v_bitop3_b32 v18, v18, v55, v15 bitop3:0xf6
    v_bitop3_b32 v18, v18, v56, v12 bitop3:0xf6
    v_bitop3_b32 v18, v18, v57, v13 bitop3:0xf6
    v_bitop3_b32 v18, v18, v58, v14 bitop3:0xf6
    v_bitop3_b32 v18, v18, v59, v15 bitop3:0xf6
    v_bitop3_b32 v18, v18, v60, v12 bitop3:0xf6
    v_bitop3_b32 v18, v18, v61, v13 bitop3:0xf6
    v_bitop3_b32 v18, v18, v62, v14 bitop3:0xf6
    v_bitop3_b32 v18, v18, v63, v15 bitop3:0xf6
    v_and_b32 v18, 0xfff, v18
    v_cmp_ne_u32 vcc, 0, v18
    s_cbranch_vccz .LF_g2
    s_sub_u32 s96, s96, 1
    s_cbranch_scc1 .LF_g2
    s_sleep 2
    s_mov_b32 s45, s44
    buffer_load_dwordx4 v[32:35], v7, s[8:11], s45 offen sc1
    s_add_u32 s45, s45, 4096
    buffer_load_dwordx4 v[36:39], v7, s[8:11], s45 offen sc1
    s_add_u32 s45, s45, 4096
    buffer_load_dwordx4 v[40:43], v7, s[8:11], s45 offen sc1
    s_add_u32 s45, s45, 4096
    buffer_load_dwordx4 v[44:47], v7, s[8:11], s45 offen sc1
    s_add_u32 s45, s45, 4096
    buffer_load_dwordx4 v[48:51], v7, s[8:11], s45 offen sc1
    s_add_u32 s45, s45, 4096
    buffer_load_dwordx4 v[52:55], v7, s[8:11], s45 offen sc1
    s_add_u32 s45, s45, 4096
    buffer_load_dwordx4 v[56:59], v7, s[8:11], s45 offen sc1
    s_add_u32 s45, s45, 4096
    buffer_load_dwordx4 v[60:63], v7, s[8:11], s45 offen sc1
    s_branch .LF_gp
.LF_g2:
    v_add_f32 v32, v32, v36
    v_add_f32 v33, v33, v37
    v_add_f32 v34, v34, v38
    v_add_f32 v35, v35, v39
    v_add_f32 v32, v32, v40
    v_add_f32 v33, v33, v41
    v_add_f32 v34, v34, v42
    v_add_f32 v35, v35, v43
    v_add_f32 v32, v32, v44
    v_add_f32 v33, v33, v45
    v_add_f32 v34, v34, v46
    v_add_f32 v35, v35, v47
    v_add_f32 v48, v48, v52
    v_add_f32 v49, v49, v53
    v_add_f32 v50, v50, v54
    v_add_f32 v51, v51, v55
    v_add_f32 v48, v48, v56
    v_add_f32 v49, v49, v57
    v_add_f32 v50, v50, v58
    v_add_f32 v51, v51, v59
    v_add_f32 v48, v48, v60
    v_add_f32 v49, v49, v61
    v_add_f32 v50, v50, v62
    v_add_f32 v51, v51, v63
    v_mov_b32 v36, v32
    v_mov_b32 v52, v48
    v_mov_b32 v37, v33
    v_mov_b32 v53, v49
    v_mov_b32 v38, v34
    v_mov_b32 v54, v50
    v_mov_b32 v39, v35
    v_mov_b32 v55, v51
    s_nop 0
    v_permlane16_swap_b32 v32, v36
    v_permlane16_swap_b32 v48, v52
    v_permlane16_swap_b32 v33, v37
    v_permlane16_swap_b32 v49, v53
    v_permlane16_swap_b32 v34, v38
    v_permlane16_swap_b32 v50, v54
    v_permlane16_swap_b32 v35, v39
    v_permlane16_swap_b32 v51, v55
    v_add_f32 v32, v32, v36
    v_add_f32 v48, v48, v52
    v_add_f32 v33, v33, v37
    v_add_f32 v49, v49, v53
    v_add_f32 v34, v34, v38
    v_add_f32 v50, v50, v54
    v_add_f32 v35, v35, v39
    v_add_f32 v51, v51, v55
    v_mov_b32 v36, v32
    v_mov_b32 v52, v48
    v_mov_b32 v37, v33
    v_mov_b32 v53, v49
    v_mov_b32 v38, v34
    v_mov_b32 v54, v50
    v_mov_b32 v39, v35
    v_mov_b32 v55, v51
    s_nop 0
    v_permlane32_swap_b32 v32, v36
    v_permlane32_swap_b32 v48, v52
    v_permlane32_swap_b32 v33, v37
    v_permlane32_swap_b32 v49, v53
    v_permlane32_swap_b32 v34, v38
    v_permlane32_swap_b32 v50, v54
    v_permlane32_swap_b32 v35, v39
    v_permlane32_swap_b32 v51, v55
    v_add_f32 v32, v32, v36
    v_add_f32 v48, v48, v52
    v_add_f32 v33, v33, v37
    v_add_f32 v49, v49, v53
    v_add_f32 v34, v34, v38
    v_add_f32 v50, v50, v54
    v_add_f32 v35, v35, v39
    v_add_f32 v51, v51, v55
    v_cvt_pk_bf16_f32 v32, v32, v48
    v_cvt_pk_bf16_f32 v33, v33, v49
    v_cvt_pk_bf16_f32 v34, v34, v50
    v_cvt_pk_bf16_f32 v35, v35, v51
    v_and_b32 v48, 0xffff0000, v32
    v_lshlrev_b32 v32, 16, v32
    v_and_b32 v49, 0xffff0000, v33
    v_lshlrev_b32 v33, 16, v33
    v_and_b32 v50, 0xffff0000, v34
    v_lshlrev_b32 v34, 16, v34
    v_and_b32 v51, 0xffff0000, v35
    v_lshlrev_b32 v35, 16, v35
    v_mul_f32 v36, 0xbfb8aa3b, v32
    v_mul_f32 v37, 0xbfb8aa3b, v33
    v_mul_f32 v38, 0xbfb8aa3b, v34
    v_mul_f32 v39, 0xbfb8aa3b, v35
    v_exp_f32 v36, v36
    v_exp_f32 v37, v37
    v_exp_f32 v38, v38
    v_exp_f32 v39, v39
    s_nop 0
    v_add_f32 v36, 1.0, v36
    v_add_f32 v37, 1.0, v37
    v_add_f32 v38, 1.0, v38
    v_add_f32 v39, 1.0, v39
    v_rcp_f32 v36, v36
    v_rcp_f32 v37, v37
    v_rcp_f32 v38, v38
    v_rcp_f32 v39, v39
    s_nop 0
    v_mul_f32 v32, v32, v36
    v_mul_f32 v33, v33, v37
    v_mul_f32 v34, v34, v38
    v_mul_f32 v35, v35, v39
    v_cvt_pk_bf16_f32 v32, v32, v33
    v_cvt_pk_bf16_f32 v34, v34, v35
    v_and_b32 v33, 0xffff0000, v32
    v_lshlrev_b32 v32, 16, v32
    v_and_b32 v35, 0xffff0000, v34
    v_lshlrev_b32 v34, 16, v34
    v_mul_f32 v32, v32, v48
    v_mul_f32 v33, v33, v49
    v_mul_f32 v34, v34, v50
    v_mul_f32 v35, v35, v51
    v_cvt_pk_bf16_f32 v32, v32, v33
    v_cvt_pk_bf16_f32 v33, v34, v35
    ds_bpermute_b32 v20, v16, v32
    ds_bpermute_b32 v21, v16, v33
    ds_bpermute_b32 v22, v17, v32
    ds_bpermute_b32 v23, v17, v33
    s_waitcnt lgkmcnt(0)
    v_mfma_f32_16x16x32_bf16 v[32:35], v[20:23], v[128:131], 0
    v_mfma_f32_16x16x32_bf16 v[36:39], v[20:23], v[132:135], 0
    v_mfma_f32_16x16x32_bf16 v[40:43], v[20:23], v[136:139], 0
    v_mfma_f32_16x16x32_bf16 v[44:47], v[20:23], v[140:143], 0
    v_mfma_f32_16x16x32_bf16 v[48:51], v[20:23], v[144:147], 0
    v_mfma_f32_16x16x32_bf16 v[52:55], v[20:23], v[148:151], 0
    v_mfma_f32_16x16x32_bf16 v[56:59], v[20:23], v[152:155], 0
    v_mfma_f32_16x16x32_bf16 v[60:63], v[20:23], v[156:159], 0
    s_nop 4
    v_cndmask_b32 v64, v32, v48, s[54:55]
    v_cndmask_b32 v65, v36, v52, s[54:55]
    v_cndmask_b32 v66, v40, v56, s[54:55]
    v_cndmask_b32 v67, v44, v60, s[54:55]
    v_cndmask_b32 v68, v33, v49, s[54:55]
    v_cndmask_b32 v69, v37, v53, s[54:55]
    v_cndmask_b32 v70, v41, v57, s[54:55]
    v_cndmask_b32 v71, v45, v61, s[54:55]
    v_cndmask_b32 v64, v64, v68, s[56:57]
    v_cndmask_b32 v65, v65, v69, s[56:57]
    v_cndmask_b32 v66, v66, v70, s[56:57]
    v_cndmask_b32 v67, v67, v71, s[56:57]
    v_bfi_b32 v64, s100, v28, v64
    v_bfi_b32 v65, s100, v29, v65
    v_bfi_b32 v66, s100, v30, v66
    v_bfi_b32 v67, s100, v31, v67
    buffer_store_dwordx4 v[64:67], v6, s[8:11], s61 offen sc1
    s_branch .LA_exit
.LA_zq:
    s_cmp_ge_u32 s43, 32
    s_cbranch_scc1 .LA_exit
    s_cmp_lg_u32 s3, 0
    s_cbranch_scc1 .LA_exit
    v_and_b32 v3, 7, v0
    v_lshrrev_b32 v2, 3, v0
    v_lshlrev_b32 v4, 12, v2
    v_lshl_add_u32 v4, v3, 4, v4
    v_mov_b32 v10, s40
    s_mov_b32 s100, 0x9E3779B1
    v_mul_lo_u32 v12, v10, s100
    v_lshrrev_b32 v11, 12, v10
    v_lshrrev_b32 v13, 20, v12
    v_lshrrev_b32 v12, 8, v12
    s_movk_i32 s100, 0xfff
    v_lshrrev_b32 v14, 4, v0
    v_lshl_add_u32 v14, v3, 2, v14
    v_lshlrev_b32 v15, 2, v14
    v_add_u32 v15, 143360, v15
    v_lshlrev_b32 v14, 1, v14
    s_lshl_b32 s45, s43, 6
    buffer_load_ushort v16, v14, s[4:7], s45 offen
    s_bfe_u32 s46, s43, 0x20002
    s_lshl_b32 s46, s46, 10
    s_lshr_b32 s48, s43, 4
    s_lshl_b32 s48, s48, 9
    s_add_u32 s46, s46, s48
    s_and_b32 s48, s43, 3
    s_lshl_b32 s48, s48, 7
    s_add_u32 s46, s46, s48
    s_add_u32 s46, s46, 2097152
    s_mov_b64 s[50:51], -1
    s_mov_b64 s[52:53], -1
    s_mov_b64 s[54:55], -1
    s_mov_b64 s[56:57], -1
    s_waitcnt vmcnt(0)
    v_lshlrev_b32 v16, 16, v16
    s_mov_b32 s96, 4000000
.LZ_s_1:
    s_sub_u32 s96, s96, 1
    s_cbranch_scc1 .LZ_s_2
    s_sleep 1
    s_mov_b64 exec, s[50:51]
    buffer_load_dwordx4 v[32:35], v4, s[8:11], s46 offen sc1
    s_waitcnt vmcnt(0)
    v_xor_b32 v20, v32, v10
    v_bitop3_b32 v20, v20, v33, v11 bitop3:0xf6
    v_bitop3_b32 v20, v20, v34, v12 bitop3:0xf6
    v_bitop3_b32 v20, v20, v35, v13 bitop3:0xf6
    v_and_b32 v20, 0xfff, v20
    v_cmp_ne_u32 s[50:51], 0, v20
    s_bcnt1_i32_b64 s48, s[50:51]
    s_cmp_gt_u32 s48, 32
    s_cbranch_scc1 .LZ_s_1
.LZ_s_2:
    s_mov_b32 s96, 4000000
.LZ_s_p:
    s_sub_u32 s96, s96, 1
    s_cbranch_scc1 .LZ_s_ok
    s_mov_b64 exec, s[50:51]
    s_cbranch_execz .LZ_s_s0
    buffer_load_dwordx4 v[32:35], v4, s[8:11], s46 offen sc1
.LZ_s_s0:
    s_mov_b64 exec, s[52:53]
    s_cbranch_execz .LZ_s_s1
    s_add_u32 s48, s46, 32768
    buffer_load_dwordx4 v[36:39], v4, s[8:11], s48 offen sc1
.LZ_s_s1:
    s_mov_b64 exec, s[54:55]
    s_cbranch_execz .LZ_s_s2
    s_add_u32 s48, s46, 65536
    buffer_load_dwordx4 v[40:43], v4, s[8:11], s48 offen sc1
.LZ_s_s2:
    s_mov_b64 exec, s[56:57]
    s_cbranch_execz .LZ_s_s3
    s_add_u32 s48, s46, 98304
    buffer_load_dwordx4 v[44:47], v4, s[8:11], s48 offen sc1
.LZ_s_s3:
    s_waitcnt vmcnt(0)
    s_mov_b64 vcc, 0
    s_mov_b64 exec, -1
    v_xor_b32 v60, v32, v10
    v_bitop3_b32 v60, v60, v33, v11 bitop3:0xf6
    v_bitop3_b32 v60, v60, v34, v12 bitop3:0xf6
    v_bitop3_b32 v60, v60, v35, v13 bitop3:0xf6
    v_xor_b32 v61, v36, v10
    v_bitop3_b32 v61, v61, v37, v11 bitop3:0xf6
    v_bitop3_b32 v61, v61, v38, v12 bitop3:0xf6
    v_bitop3_b32 v61, v61, v39, v13 bitop3:0xf6
    v_xor_b32 v62, v40, v10
    v_bitop3_b32 v62, v62, v41, v11 bitop3:0xf6
    v_bitop3_b32 v62, v62, v42, v12 bitop3:0xf6
    v_bitop3_b32 v62, v62, v43, v13 bitop3:0xf6
    v_xor_b32 v63, v44, v10
    v_bitop3_b32 v63, v63, v45, v11 bitop3:0xf6
    v_bitop3_b32 v63, v63, v46, v12 bitop3:0xf6
    v_bitop3_b32 v63, v63, v47, v13 bitop3:0xf6
    v_and_b32 v60, 0xfff, v60
    v_and_b32 v61, 0xfff, v61
    v_and_b32 v62, 0xfff, v62
    v_and_b32 v63, 0xfff, v63
    s_mov_b64 exec, s[50:51]
    v_cmp_ne_u32 s[50:51], 0, v60
    s_or_b64 vcc, vcc, s[50:51]
    s_mov_b64 exec, s[52:53]
    v_cmp_ne_u32 s[52:53], 0, v61
    s_or_b64 vcc, vcc, s[52:53]
    s_mov_b64 exec, s[54:55]
    v_cmp_ne_u32 s[54:55], 0, v62
    s_or_b64 vcc, vcc, s[54:55]
    s_mov_b64 exec, s[56:57]
    v_cmp_ne_u32 s[56:57], 0, v63
    s_or_b64 vcc, vcc, s[56:57]
    s_cbranch_vccnz .LZ_s_p
.LZ_s_ok:
    s_mov_b64 exec, -1
    s_barrier
    ds_read_b32 v24, v15
    v_pk_add_f32 v[32:33], v[32:33], v[36:37]
    v_pk_add_f32 v[40:41], v[40:41], v[44:45]
    v_pk_add_f32 v[34:35], v[34:35], v[38:39]
    v_pk_add_f32 v[42:43], v[42:43], v[46:47]
    v_pk_add_f32 v[32:33], v[32:33], v[40:41]
    v_pk_add_f32 v[34:35], v[34:35], v[42:43]
    s_nop 1
    v_permlane32_swap_b32 v32, v34
    v_permlane32_swap_b32 v33, v35
    v_add_f32 v32, v32, v34
    v_add_f32 v33, v33, v35
    s_nop 1
    v_permlane16_swap_b32 v32, v33
    v_add_f32 v32, v32, v33
    s_nop 1
    v_add_f32_dpp v32, v32, v32 row_ror:8 row_mask:0xf bank_mask:0xf
    s_mov_b32 exec_lo, 0x00ff00ff
    s_mov_b32 exec_hi, 0x00ff00ff
    v_cvt_pk_bf16_f32 v32, v32, v32
    v_lshlrev_b32 v32, 16, v32
    s_waitcnt lgkmcnt(0)
    v_mul_f32 v32, v32, v24
    v_cvt_pk_bf16_f32 v32, v32, v32
    v_lshlrev_b32 v32, 16, v32
    v_add_f32 v32, v32, v16
    v_cvt_pk_bf16_f32 v32, v32, v32
    buffer_store_short v32, v14, s[32:35], s45 offen
.LA_exit:
.L_end:
    s_endpgm
.L_codeend:
.section .rodata,"a"
.p2align 6
.amdhsa_kernel recurrent_scan__compressed_kv_cla__glu_gated_swiglu__decode_kernel
  .amdhsa_next_free_vgpr 256
  .amdhsa_next_free_sgpr 102
  .amdhsa_accum_offset 256
  .amdhsa_group_segment_fixed_size 0
  .amdhsa_kernarg_size 104
  .amdhsa_user_sgpr_count 2
  .amdhsa_user_sgpr_kernarg_segment_ptr 1
  .amdhsa_system_sgpr_workgroup_id_x 1
.end_amdhsa_kernel
```
